```python
import torch

def _softmax(x, axis=-1):
    return torch.softmax(x, dim=axis)
def _gelu(x):
    return torch.nn.functional.gelu(x, approximate="tanh")
def _silu(x):
    return torch.nn.functional.silu(x)
def _sigmoid(x):
    return torch.sigmoid(x)
def _layernorm(x, axis=-1, eps=1e-5):
    m = x.mean(dim=axis, keepdim=True)
    v = x.var(dim=axis, keepdim=True, unbiased=False)
    return (x - m) / torch.sqrt(v + eps)
def _scatter_add(tgt, idx, src, axis=0):
    return tgt.clone().index_add_(axis, idx, src)
def _segment_sum(src, seg, n):
    out = torch.zeros((n,) + src.shape[1:], dtype=src.dtype)
    return out.index_add_(0, seg, src)
def _pad(x, pw):
    flat = tuple(v for pair in reversed(pw) for v in pair)
    return torch.nn.functional.pad(x, flat)

kernel_name = 'standalone__mha_block_cached__near_ridge'

def setup_inputs():

    _w = (lambda a: (lambda t: t.to(torch.bfloat16) if t.is_floating_point() else t)(torch.as_tensor(a)))
    B, Sq, D = 8, 80, 1024
    H, Sk, Dh = 32, 80, 128
    return {
        "x": _w((lambda *s: torch.randn(*s, dtype=torch.bfloat16) * 0.8)(B, Sq, D)),
        "k_cache": _w((lambda *s: torch.randn(*s, dtype=torch.bfloat16) * 0.8)(B, H, Sk, Dh)),
        "v_cache": _w((lambda *s: torch.randn(*s, dtype=torch.bfloat16) * 0.05)(B, H, Sk, Dh)),
        "wq": _w((lambda *s: torch.randn(*s, dtype=torch.bfloat16) * 0.8)(D, H * Dh) * (D ** -0.5)),
        "wo": _w((lambda *s: torch.randn(*s, dtype=torch.bfloat16) * 0.05)(H * Dh, D) * ((H * Dh) ** -0.5)),
    }

def reference(x, k_cache, v_cache, wq, wo):
    B, Sq, D = x.shape
    H, Dh = 32, 128
    q = (lambda x, *d: x.permute(*d))((x @ wq).reshape(B, Sq, H, Dh), 0, 2, 1, 3)
    scores = torch.einsum("bhqd,bhkd->bhqk", q, k_cache) * (Dh ** -0.5)
    p = _softmax(scores, axis=-1)
    o = torch.einsum("bhqk,bhkd->bhqd", p, v_cache)
    return (lambda x, *d: x.permute(*d))(o, 0, 2, 1, 3).reshape(B, Sq, H * Dh) @ wo
```

```asm
; @launch grid=(256,1,1) block=(256,1,1) lds=163840
.amdgcn_target "amdgcn-amd-amdhsa--gfx950"
.text
.globl standalone__mha_block_cached__near_ridge_kernel
.p2align 8
.type standalone__mha_block_cached__near_ridge_kernel,@function
standalone__mha_block_cached__near_ridge_kernel:
    s_cmp_ge_u32 s2, 256
    s_cbranch_scc1 L_end
    s_load_dwordx16 s[4:19], s[0:1], 0
    s_getpc_b64 s[84:85]
L_pc:
    s_lshr_b32 s3, s2, 3
    v_lshrrev_b32 v10, 5, v0
    v_lshl_add_u32 v10, s3, 3, v10
    v_lshlrev_b32 v10, 7, v10
    v_min_u32 v10, L_last-L_pc, v10
    v_mov_b32 v9, s85
    v_add_co_u32 v8, vcc, s84, v10
    s_nop 1
    v_addc_co_u32 v9, vcc, 0, v9, vcc
    global_load_dword v12, v[8:9], off
    v_lshrrev_b32 v6, 6, v0
    v_and_b32 v1, 63, v0
    v_readfirstlane_b32 s20, v6
    v_and_b32 v2, 15, v0
    v_lshrrev_b32 v3, 4, v1
    v_lshrrev_b32 v6, 4, v0
    s_and_b32 s69, s2, 7
    s_lshr_b32 s21, s2, 5
    s_bfe_u32 s81, s2, 0x20003
    s_lshl_b32 s3, s69, 2
    s_add_u32 s22, s81, s3
    s_add_u32 s23, s69, s21
    s_lshl_b32 s68, s20, 10
    s_mul_i32 s84, s21, 163840
    s_lshl_b32 s85, s22, 8
    v_xor_b32 v8, v2, v6
    v_lshlrev_b32 v8, 4, v8
    v_lshl_add_u32 v13, v6, 11, v8
    v_lshl_add_u32 v26, v6, 8, v8
    v_add_u32 v14, 32768, v13
    v_add_u32 v15, 65536, v13
    v_add_u32 v16, 98304, v13
    v_add_u32 v17, 131072, v13
    v_lshrrev_b32 v9, 3, v6
    v_lshl_or_b32 v9, v9, 2, v3
    v_lshlrev_b32 v9, 1, v9
    v_xor_b32 v9, v2, v9
    v_lshlrev_b32 v9, 4, v9
    v_lshl_add_u32 v18, v6, 13, v9
    v_add_u32 v19, 131072, v18
    v_add_u32 v20, 262144, v18
    v_add_u32 v21, 393216, v18
    v_add_u32 v22, 524288, v18
    v_add_u32 v23, 655360, v18
    v_add_u32 v24, 786432, v18
    v_add_u32 v25, 917504, v18
    s_waitcnt lgkmcnt(0)
    s_add_u32 s24, s4, s84
    s_addc_u32 s25, s5, 0
    s_and_b32 s25, s25, 0xffff
    s_mov_b32 s26, 163840
    s_mov_b32 s27, 0x20000
    s_add_u32 s28, s10, s85
    s_addc_u32 s29, s11, 0
    s_and_b32 s29, s29, 0xffff
    s_mov_b32 s30, 8380672
    s_mov_b32 s31, 0x20000
    s_add_u32 s3, s23, 0
    s_and_b32 s3, s3, 7
    s_lshl_b32 s70, s3, 8
    s_lshl_b32 s71, s3, 20
    s_add_u32 m0, s68, 0
    s_nop 0
    buffer_load_dwordx4 v13, s[24:27], s70 offen lds
    s_add_u32 m0, s68, 4096
    s_nop 0
    buffer_load_dwordx4 v14, s[24:27], s70 offen lds
    s_add_u32 m0, s68, 8192
    s_nop 0
    buffer_load_dwordx4 v15, s[24:27], s70 offen lds
    s_add_u32 m0, s68, 12288
    s_nop 0
    buffer_load_dwordx4 v16, s[24:27], s70 offen lds
    s_add_u32 m0, s68, 16384
    s_nop 0
    buffer_load_dwordx4 v17, s[24:27], s70 offen lds
    s_add_u32 m0, s68, 20480
    s_nop 0
    buffer_load_dwordx4 v18, s[28:31], s71 offen lds
    s_add_u32 m0, s68, 24576
    s_nop 0
    buffer_load_dwordx4 v19, s[28:31], s71 offen lds
    s_add_u32 m0, s68, 28672
    s_nop 0
    buffer_load_dwordx4 v20, s[28:31], s71 offen lds
    s_add_u32 m0, s68, 32768
    s_nop 0
    buffer_load_dwordx4 v21, s[28:31], s71 offen lds
    s_add_u32 m0, s68, 36864
    s_nop 0
    buffer_load_dwordx4 v22, s[28:31], s71 offen lds
    s_add_u32 s52, s18, 6291456
    s_addc_u32 s53, s19, 0
    s_and_b32 s53, s53, 0xffff
    s_mov_b32 s54, 65536
    s_mov_b32 s55, 0x20000
    s_lshl_b32 s3, s2, 7
    s_lshl_b32 s83, s20, 2
    s_add_u32 s3, s3, s83
    v_lshlrev_b32 v28, 20, v1
    v_add_u32 v28, s3, v28
    s_lshl_b32 s3, s21, 7
    s_add_u32 s3, s3, 32768
    v_mov_b32 v29, s3
    v_bfe_u32 v4, v0, 2, 2
    v_and_b32 v5, 3, v0
    v_lshlrev_b32 v7, 4, v1
    s_lshr_b32 s77, s69, 1
    s_and_b32 s3, s69, 1
    s_lshl_b32 s3, s3, 2
    s_add_u32 s78, s3, s81
    s_lshl_b32 s3, s21, 5
    s_add_u32 s83, s3, s22
    s_mul_i32 s83, s83, 20480
    s_add_u32 s32, s6, s83
    s_addc_u32 s33, s7, 0
    s_and_b32 s33, s33, 0xffff
    s_mov_b32 s34, 20480
    s_mov_b32 s35, 0x20000
    s_add_u32 s36, s8, s83
    s_addc_u32 s37, s9, 0
    s_and_b32 s37, s37, 0xffff
    s_mov_b32 s38, 20480
    s_mov_b32 s39, 0x20000
    s_add_u32 s40, s18, s83
    s_addc_u32 s41, s19, 0
    s_and_b32 s41, s41, 0xffff
    s_mov_b32 s42, 20480
    s_mov_b32 s43, 0x20000
    s_lshl_b32 s83, s77, 3
    s_add_u32 s83, s83, s3
    s_mul_i32 s83, s83, 20480
    s_add_u32 s48, s18, s83
    s_addc_u32 s49, s19, 0
    s_and_b32 s49, s49, 0xffff
    s_mov_b32 s50, 163840
    s_mov_b32 s51, 0x20000
    s_lshl_b32 s83, s77, 21
    s_lshl_b32 s3, s78, 8
    s_add_u32 s83, s83, s3
    s_add_u32 s44, s12, s83
    s_addc_u32 s45, s13, 0
    s_and_b32 s45, s45, 0xffff
    s_mov_b32 s46, 2095360
    s_mov_b32 s47, 0x20000
    s_add_u32 s83, s84, s3
    s_lshl_b32 s3, s20, 6
    s_add_u32 s83, s83, s3
    s_add_u32 s64, s14, s83
    s_addc_u32 s65, s15, 0
    s_and_b32 s65, s65, 0xffff
    s_mov_b32 s66, 161856
    s_mov_b32 s67, 0x20000
    s_add_u32 s60, s18, 8388608
    s_addc_u32 s61, s19, 0
    s_and_b32 s61, s61, 0xffff
    s_mov_b32 s62, 16777216
    s_mov_b32 s63, 0x20000
    s_mov_b32 s72, 0
    s_mov_b32 s73, 4096
    s_mov_b32 s74, 8192
    s_mov_b32 s75, 12288
    s_mov_b32 s76, 16384
    s_mov_b32 s80, 0x3e0293ee
    s_mov_b32 s82, 1048576
    s_max_u32 s79, s21, 1
    v_and_b32 v9, 7, v6
    v_lshlrev_b32 v9, 1, v9
    v_xor_b32 v9, v2, v9
    v_lshlrev_b32 v9, 4, v9
    v_lshl_add_u32 v27, v6, 8, v9
    v_lshl_add_u32 v31, v6, 11, v9
    v_add_u32 v32, 32768, v31
    v_add_u32 v33, 65536, v31
    v_add_u32 v34, 98304, v31
    v_add_u32 v35, 131072, v31
    v_add_u32 v36, 163840, v31
    v_add_u32 v37, 196608, v31
    v_add_u32 v38, 229376, v31
    v_or_b32 v8, 0, v3
    v_xor_b32 v8, v8, v2
    v_lshlrev_b32 v8, 4, v8
    v_lshl_add_u32 v39, v2, 8, v8
    v_add_u32 v40, 0x10000, v39
    v_add_u32 v41, 0x20000, v39
    v_or_b32 v8, 4, v3
    v_xor_b32 v8, v8, v2
    v_lshlrev_b32 v8, 4, v8
    v_lshl_add_u32 v42, v2, 8, v8
    v_add_u32 v43, 0x10000, v42
    v_add_u32 v44, 0x20000, v42
    v_or_b32 v8, 8, v3
    v_xor_b32 v8, v8, v2
    v_lshlrev_b32 v8, 4, v8
    v_lshl_add_u32 v45, v2, 8, v8
    v_add_u32 v46, 0x10000, v45
    v_add_u32 v47, 0x20000, v45
    v_or_b32 v8, 12, v3
    v_xor_b32 v8, v8, v2
    v_lshlrev_b32 v8, 4, v8
    v_lshl_add_u32 v48, v2, 8, v8
    v_add_u32 v49, 0x10000, v48
    v_add_u32 v50, 0x20000, v48
    v_and_b32 v8, 1, v3
    v_lshl_or_b32 v8, v8, 2, v4
    v_lshl_add_u32 v9, v3, 3, v4
    v_lshlrev_b32 v9, 8, v9
    v_lshl_add_u32 v9, v5, 3, v9
    s_lshl_b32 s3, s20, 1
    s_add_u32 s83, s3, 0
    v_xor_b32 v10, s83, v8
    v_lshl_add_u32 v51, v10, 5, v9
    v_add_u32 v52, 0x10000, v51
    v_add_u32 v53, 0x20000, v51
    s_add_u32 s83, s3, 1
    v_xor_b32 v10, s83, v8
    v_lshl_add_u32 v54, v10, 5, v9
    v_add_u32 v55, 0x10000, v54
    v_add_u32 v56, 0x20000, v54
    v_lshrrev_b32 v8, 1, v3
    v_xor_b32 v8, v8, v2
    v_lshlrev_b32 v8, 4, v8
    v_lshl_add_u32 v8, v2, 8, v8
    v_and_b32 v9, 1, v3
    v_lshl_add_u32 v8, v9, 3, v8
    v_add_u32 v57, 106496, v8
    v_xor_b32 v58, 32, v57
    v_xor_b32 v59, 64, v57
    v_xor_b32 v60, 96, v57
    v_xor_b32 v61, 128, v57
    v_xor_b32 v62, 160, v57
    v_xor_b32 v63, 192, v57
    v_xor_b32 v64, 224, v57
    v_lshl_add_u32 v8, v3, 2, v4
    v_and_b32 v9, 7, v8
    v_lshlrev_b32 v9, 5, v9
    v_lshl_add_u32 v8, v8, 8, v9
    v_lshl_add_u32 v75, v5, 3, v8
    v_add_u32 v8, 126976, v75
    s_lshl_b32 s3, s20, 1
    s_add_u32 s3, s3, 0
    s_and_b32 s3, s3, 7
    s_lshl_b32 s3, s3, 5
    v_xor_b32 v65, s3, v8
    s_lshl_b32 s3, s20, 1
    s_add_u32 s3, s3, 1
    s_and_b32 s3, s3, 7
    s_lshl_b32 s3, s3, 5
    v_xor_b32 v66, s3, v8
    s_lshl_b32 s3, s20, 1
    s_add_u32 s3, s3, 2
    s_and_b32 s3, s3, 7
    s_lshl_b32 s3, s3, 5
    v_xor_b32 v67, s3, v8
    s_lshl_b32 s3, s20, 1
    s_add_u32 s3, s3, 3
    s_and_b32 s3, s3, 7
    s_lshl_b32 s3, s3, 5
    v_xor_b32 v68, s3, v8
    s_lshl_b32 s3, s20, 1
    s_add_u32 s3, s3, 4
    s_and_b32 s3, s3, 7
    s_lshl_b32 s3, s3, 5
    v_xor_b32 v69, s3, v8
    s_lshl_b32 s3, s20, 1
    s_add_u32 s3, s3, 5
    s_and_b32 s3, s3, 7
    s_lshl_b32 s3, s3, 5
    v_xor_b32 v70, s3, v8
    s_lshl_b32 s3, s20, 1
    s_add_u32 s3, s3, 6
    s_and_b32 s3, s3, 7
    s_lshl_b32 s3, s3, 5
    v_xor_b32 v71, s3, v8
    s_lshl_b32 s3, s20, 1
    s_add_u32 s3, s3, 7
    s_and_b32 s3, s3, 7
    s_lshl_b32 s3, s3, 5
    v_xor_b32 v72, s3, v8
    v_add_u32 v74, s68, v7
    s_lshl_b32 s3, s20, 12
    v_add_u32 v73, s3, v7
    s_lshl_b32 s3, s21, 5
    v_bfe_u32 v9, v0, 4, 1
    v_lshl_add_u32 v8, v4, 3, v9
    s_lshl_b32 s83, s77, 1
    s_add_u32 s83, s83, s3
    v_add_u32 v8, s83, v8
    v_lshlrev_b32 v8, 7, v8
    v_lshl_add_u32 v76, v5, 2, v8
    s_and_b32 s86, s2, 0xf9
    s_lshl_b32 s87, s77, 2
    s_add_u32 s87, s87, s20
    s_add_u32 s3, s77, 1
    s_and_b32 s3, s3, 3
    s_lshl_b32 s3, s3, 1
    s_add_u32 s3, s3, s86
    s_lshl_b32 s3, s3, 4
    s_add_u32 s3, s3, s87
    s_lshl_b32 s88, s3, 12
    s_add_u32 s3, s77, 2
    s_and_b32 s3, s3, 3
    s_lshl_b32 s3, s3, 1
    s_add_u32 s3, s3, s86
    s_lshl_b32 s3, s3, 4
    s_add_u32 s3, s3, s87
    s_lshl_b32 s89, s3, 12
    s_add_u32 s3, s77, 3
    s_and_b32 s3, s3, 3
    s_lshl_b32 s3, s3, 1
    s_add_u32 s3, s3, s86
    s_lshl_b32 s3, s3, 4
    s_add_u32 s3, s3, s87
    s_lshl_b32 s90, s3, 12
    s_mov_b32 s3, s20
    s_and_b32 s3, s3, 3
    s_lshl_b32 s3, s3, 1
    s_add_u32 s3, s3, s86
    s_lshl_b32 s3, s3, 4
    s_add_u32 s3, s3, s87
    s_lshl_b32 s91, s3, 12
    s_add_u32 s3, s77, 1
    s_and_b32 s3, s3, 3
    s_lshl_b32 s83, s2, 2
    s_add_u32 s3, s3, s83
    s_lshl_b32 s3, s3, 2
    s_add_u32 s3, s3, s20
    s_lshl_b32 s92, s3, 12
    s_add_u32 s3, s77, 2
    s_and_b32 s3, s3, 3
    s_lshl_b32 s83, s2, 2
    s_add_u32 s3, s3, s83
    s_lshl_b32 s3, s3, 2
    s_add_u32 s3, s3, s20
    s_lshl_b32 s93, s3, 12
    s_add_u32 s3, s77, 3
    s_and_b32 s3, s3, 3
    s_lshl_b32 s83, s2, 2
    s_add_u32 s3, s3, s83
    s_lshl_b32 s3, s3, 2
    s_add_u32 s3, s3, s20
    s_lshl_b32 s94, s3, 12
    v_add_u32 v78, 98304, v7
    s_add_u32 s3, s20, 0
    s_and_b32 s3, s3, 3
    s_mul_i32 s3, s3, 5
    s_add_u32 s3, s3, s20
    s_lshl_b32 s56, s3, 10
    v_add_u32 v79, s56, v78
    s_add_u32 s3, s20, 1
    s_and_b32 s3, s3, 3
    s_mul_i32 s3, s3, 5
    s_add_u32 s3, s3, s20
    s_lshl_b32 s57, s3, 10
    v_add_u32 v80, s57, v78
    s_add_u32 s3, s20, 2
    s_and_b32 s3, s3, 3
    s_mul_i32 s3, s3, 5
    s_add_u32 s3, s3, s20
    s_lshl_b32 s58, s3, 10
    v_add_u32 v81, s58, v78
    s_add_u32 s3, s20, 3
    s_and_b32 s3, s3, 3
    s_mul_i32 s3, s3, 5
    s_add_u32 s3, s3, s20
    s_lshl_b32 s59, s3, 10
    v_add_u32 v82, s59, v78
    s_mul_i32 s3, s20, 5
    s_add_u32 s3, s3, 4
    s_lshl_b32 s85, s3, 10
    s_add_u32 m0, s68, 40960
    v_add_u32 v83, s85, v78
    buffer_load_dwordx4 v23, s[28:31], s71 offen lds
    s_add_u32 m0, s68, 45056
    s_nop 0
    buffer_load_dwordx4 v24, s[28:31], s71 offen lds
    s_add_u32 m0, s68, 49152
    s_nop 0
    buffer_load_dwordx4 v25, s[28:31], s71 offen lds
    buffer_load_dword v30, v29, s[52:55], 0 offen sc1
    s_add_u32 s3, s23, 1
    s_and_b32 s3, s3, 7
    s_lshl_b32 s70, s3, 8
    s_lshl_b32 s71, s3, 20
    s_add_u32 m0, s68, 53248
    s_nop 0
    buffer_load_dwordx4 v13, s[24:27], s70 offen lds
    s_add_u32 m0, s68, 57344
    s_nop 0
    buffer_load_dwordx4 v14, s[24:27], s70 offen lds
    s_add_u32 m0, s68, 61440
    s_nop 0
    buffer_load_dwordx4 v15, s[24:27], s70 offen lds
    s_add_u32 m0, s68, 65536
    s_nop 0
    buffer_load_dwordx4 v16, s[24:27], s70 offen lds
    s_add_u32 m0, s68, 69632
    s_nop 0
    buffer_load_dwordx4 v17, s[24:27], s70 offen lds
    s_add_u32 m0, s68, 73728
    s_nop 0
    buffer_load_dwordx4 v18, s[28:31], s71 offen lds
    s_add_u32 m0, s68, 77824
    s_nop 0
    buffer_load_dwordx4 v19, s[28:31], s71 offen lds
    s_add_u32 m0, s68, 81920
    s_nop 0
    buffer_load_dwordx4 v20, s[28:31], s71 offen lds
    s_add_u32 m0, s68, 86016
    s_nop 0
    buffer_load_dwordx4 v21, s[28:31], s71 offen lds
    s_add_u32 m0, s68, 90112
    s_nop 0
    buffer_load_dwordx4 v22, s[28:31], s71 offen lds
    s_add_u32 m0, s68, 94208
    s_nop 0
    buffer_load_dwordx4 v23, s[28:31], s71 offen lds
    s_add_u32 m0, s68, 98304
    s_nop 0
    buffer_load_dwordx4 v24, s[28:31], s71 offen lds
    s_add_u32 m0, s68, 102400
    s_nop 0
    buffer_load_dwordx4 v25, s[28:31], s71 offen lds
    s_waitcnt vmcnt(14)
    s_barrier
    ds_read_b64_tr_b16 v[164:165], v51 offset:20480
    ds_read_b64_tr_b16 v[166:167], v51 offset:21504
    ds_read_b128 v[124:127], v39 offset:0
    ds_read_b64_tr_b16 v[168:169], v54 offset:20480
    ds_read_b64_tr_b16 v[170:171], v54 offset:21504
    ds_read_b128 v[128:131], v39 offset:4096
    ds_read_b128 v[132:135], v39 offset:8192
    ds_read_b128 v[136:139], v39 offset:12288
    ds_read_b128 v[140:143], v39 offset:16384
    s_add_u32 s3, s23, 2
    s_and_b32 s3, s3, 7
    s_lshl_b32 s70, s3, 8
    s_lshl_b32 s71, s3, 20
    s_add_u32 m0, s68, 106496
    s_nop 0
    buffer_load_dwordx4 v13, s[24:27], s70 offen lds
    s_add_u32 m0, s68, 110592
    s_nop 0
    buffer_load_dwordx4 v14, s[24:27], s70 offen lds
    s_add_u32 m0, s68, 114688
    s_nop 0
    buffer_load_dwordx4 v15, s[24:27], s70 offen lds
    s_waitcnt lgkmcnt(4)
    v_mfma_f32_16x16x32_bf16 v[84:87], v[164:167], v[124:127], 0
    ds_read_b64_tr_b16 v[172:173], v51 offset:28672
    s_add_u32 m0, s68, 118784
    v_mfma_f32_16x16x32_bf16 v[104:107], v[168:171], v[124:127], 0
    buffer_load_dwordx4 v16, s[24:27], s70 offen lds
    ds_read_b64_tr_b16 v[174:175], v51 offset:29696
    s_waitcnt lgkmcnt(4)
    v_mfma_f32_16x16x32_bf16 v[88:91], v[164:167], v[128:131], 0
    ds_read_b128 v[144:147], v42 offset:0
    v_mfma_f32_16x16x32_bf16 v[108:111], v[168:171], v[128:131], 0
    s_add_u32 m0, s68, 122880
    ds_read_b64_tr_b16 v[176:177], v54 offset:28672
    buffer_load_dwordx4 v17, s[24:27], s70 offen lds
    v_mfma_f32_16x16x32_bf16 v[92:95], v[164:167], v[132:135], 0
    ds_read_b64_tr_b16 v[178:179], v54 offset:29696
    v_mfma_f32_16x16x32_bf16 v[112:115], v[168:171], v[132:135], 0
    ds_read_b128 v[148:151], v42 offset:4096
    s_waitcnt lgkmcnt(6)
    v_mfma_f32_16x16x32_bf16 v[96:99], v[164:167], v[136:139], 0
    s_add_u32 m0, s68, 126976
    ds_read_b128 v[152:155], v42 offset:8192
    buffer_load_dwordx4 v18, s[28:31], s71 offen lds
    v_mfma_f32_16x16x32_bf16 v[116:119], v[168:171], v[136:139], 0
    ds_read_b128 v[156:159], v42 offset:12288
    v_mfma_f32_16x16x32_bf16 v[100:103], v[164:167], v[140:143], 0
    ds_read_b128 v[160:163], v42 offset:16384
    v_mfma_f32_16x16x32_bf16 v[120:123], v[168:171], v[140:143], 0
    s_waitcnt lgkmcnt(4)
    v_mfma_f32_16x16x32_bf16 v[84:87], v[172:175], v[144:147], v[84:87]
    ds_read_b64_tr_b16 v[164:165], v51 offset:36864
    s_add_u32 m0, s68, 131072
    v_mfma_f32_16x16x32_bf16 v[104:107], v[176:179], v[144:147], v[104:107]
    buffer_load_dwordx4 v19, s[28:31], s71 offen lds
    ds_read_b64_tr_b16 v[166:167], v51 offset:37888
    s_waitcnt lgkmcnt(4)
    v_mfma_f32_16x16x32_bf16 v[88:91], v[172:175], v[148:151], v[88:91]
    ds_read_b128 v[124:127], v45 offset:0
    v_mfma_f32_16x16x32_bf16 v[108:111], v[176:179], v[148:151], v[108:111]
    s_add_u32 m0, s68, 135168
    ds_read_b64_tr_b16 v[168:169], v54 offset:36864
    buffer_load_dwordx4 v20, s[28:31], s71 offen lds
    v_mfma_f32_16x16x32_bf16 v[92:95], v[172:175], v[152:155], v[92:95]
    ds_read_b64_tr_b16 v[170:171], v54 offset:37888
    v_mfma_f32_16x16x32_bf16 v[112:115], v[176:179], v[152:155], v[112:115]
    ds_read_b128 v[128:131], v45 offset:4096
    s_waitcnt lgkmcnt(6)
    v_mfma_f32_16x16x32_bf16 v[96:99], v[172:175], v[156:159], v[96:99]
    s_add_u32 m0, s68, 139264
    ds_read_b128 v[132:135], v45 offset:8192
    buffer_load_dwordx4 v21, s[28:31], s71 offen lds
    v_mfma_f32_16x16x32_bf16 v[116:119], v[176:179], v[156:159], v[116:119]
    ds_read_b128 v[136:139], v45 offset:12288
    v_mfma_f32_16x16x32_bf16 v[100:103], v[172:175], v[160:163], v[100:103]
    ds_read_b128 v[140:143], v45 offset:16384
    v_mfma_f32_16x16x32_bf16 v[120:123], v[176:179], v[160:163], v[120:123]
    s_waitcnt lgkmcnt(4)
    v_mfma_f32_16x16x32_bf16 v[84:87], v[164:167], v[124:127], v[84:87]
    ds_read_b64_tr_b16 v[172:173], v51 offset:45056
    s_add_u32 m0, s68, 143360
    v_mfma_f32_16x16x32_bf16 v[104:107], v[168:171], v[124:127], v[104:107]
    buffer_load_dwordx4 v22, s[28:31], s71 offen lds
    ds_read_b64_tr_b16 v[174:175], v51 offset:46080
    s_waitcnt lgkmcnt(4)
    v_mfma_f32_16x16x32_bf16 v[88:91], v[164:167], v[128:131], v[88:91]
    ds_read_b128 v[144:147], v48 offset:0
    s_add_u32 m0, s68, 147456
    v_mfma_f32_16x16x32_bf16 v[108:111], v[168:171], v[128:131], v[108:111]
    buffer_load_dwordx4 v23, s[28:31], s71 offen lds
    ds_read_b64_tr_b16 v[176:177], v54 offset:45056
    v_mfma_f32_16x16x32_bf16 v[92:95], v[164:167], v[132:135], v[92:95]
    ds_read_b64_tr_b16 v[178:179], v54 offset:46080
    s_add_u32 m0, s68, 151552
    v_mfma_f32_16x16x32_bf16 v[112:115], v[168:171], v[132:135], v[112:115]
    buffer_load_dwordx4 v24, s[28:31], s71 offen lds
    ds_read_b128 v[148:151], v48 offset:4096
    s_waitcnt lgkmcnt(6)
    v_mfma_f32_16x16x32_bf16 v[96:99], v[164:167], v[136:139], v[96:99]
    ds_read_b128 v[152:155], v48 offset:8192
    s_add_u32 m0, s68, 155648
    v_mfma_f32_16x16x32_bf16 v[116:119], v[168:171], v[136:139], v[116:119]
    buffer_load_dwordx4 v25, s[28:31], s71 offen lds
    ds_read_b128 v[156:159], v48 offset:12288
    v_mfma_f32_16x16x32_bf16 v[100:103], v[164:167], v[140:143], v[100:103]
    ds_read_b128 v[160:163], v48 offset:16384
    v_mfma_f32_16x16x32_bf16 v[120:123], v[168:171], v[140:143], v[120:123]
    s_waitcnt vmcnt(13) lgkmcnt(0)
    s_barrier
    v_mfma_f32_16x16x32_bf16 v[84:87], v[172:175], v[144:147], v[84:87]
    s_add_u32 s3, s23, 3
    s_and_b32 s3, s3, 7
    s_lshl_b32 s70, s3, 8
    s_lshl_b32 s71, s3, 20
    s_add_u32 m0, s68, 0
    s_nop 0
    buffer_load_dwordx4 v13, s[24:27], s70 offen lds
    ds_read_b64_tr_b16 v[164:165], v52 offset:8192
    v_mfma_f32_16x16x32_bf16 v[104:107], v[176:179], v[144:147], v[104:107]
    ds_read_b64_tr_b16 v[166:167], v52 offset:9216
    v_mfma_f32_16x16x32_bf16 v[88:91], v[172:175], v[148:151], v[88:91]
    ds_read_b128 v[124:127], v39 offset:53248
    s_add_u32 m0, s68, 4096
    v_mfma_f32_16x16x32_bf16 v[108:111], v[176:179], v[148:151], v[108:111]
    buffer_load_dwordx4 v14, s[24:27], s70 offen lds
    ds_read_b64_tr_b16 v[168:169], v55 offset:8192
    v_mfma_f32_16x16x32_bf16 v[92:95], v[172:175], v[152:155], v[92:95]
    ds_read_b64_tr_b16 v[170:171], v55 offset:9216
    v_mfma_f32_16x16x32_bf16 v[112:115], v[176:179], v[152:155], v[112:115]
    ds_read_b128 v[128:131], v39 offset:57344
    v_mfma_f32_16x16x32_bf16 v[96:99], v[172:175], v[156:159], v[96:99]
    ds_read_b128 v[132:135], v39 offset:61440
    s_add_u32 m0, s68, 8192
    v_mfma_f32_16x16x32_bf16 v[116:119], v[176:179], v[156:159], v[116:119]
    buffer_load_dwordx4 v15, s[24:27], s70 offen lds
    ds_read_b128 v[136:139], v40 offset:0
    v_mfma_f32_16x16x32_bf16 v[100:103], v[172:175], v[160:163], v[100:103]
    ds_read_b128 v[140:143], v40 offset:4096
    v_mfma_f32_16x16x32_bf16 v[120:123], v[176:179], v[160:163], v[120:123]
    s_waitcnt lgkmcnt(4)
    s_add_u32 m0, s68, 12288
    v_mfma_f32_16x16x32_bf16 v[84:87], v[164:167], v[124:127], v[84:87]
    buffer_load_dwordx4 v16, s[24:27], s70 offen lds
    ds_read_b64_tr_b16 v[172:173], v52 offset:16384
    v_mfma_f32_16x16x32_bf16 v[104:107], v[168:171], v[124:127], v[104:107]
    ds_read_b64_tr_b16 v[174:175], v52 offset:17408
    s_waitcnt lgkmcnt(4)
    v_mfma_f32_16x16x32_bf16 v[88:91], v[164:167], v[128:131], v[88:91]
    ds_read_b128 v[144:147], v42 offset:53248
    s_add_u32 m0, s68, 16384
    v_mfma_f32_16x16x32_bf16 v[108:111], v[168:171], v[128:131], v[108:111]
    buffer_load_dwordx4 v17, s[24:27], s70 offen lds
    ds_read_b64_tr_b16 v[176:177], v55 offset:16384
    v_mfma_f32_16x16x32_bf16 v[92:95], v[164:167], v[132:135], v[92:95]
    ds_read_b64_tr_b16 v[178:179], v55 offset:17408
    v_mfma_f32_16x16x32_bf16 v[112:115], v[168:171], v[132:135], v[112:115]
    ds_read_b128 v[148:151], v42 offset:57344
    s_waitcnt lgkmcnt(6)
    s_add_u32 m0, s68, 20480
    v_mfma_f32_16x16x32_bf16 v[96:99], v[164:167], v[136:139], v[96:99]
    buffer_load_dwordx4 v18, s[28:31], s71 offen lds
    ds_read_b128 v[152:155], v42 offset:61440
    v_mfma_f32_16x16x32_bf16 v[116:119], v[168:171], v[136:139], v[116:119]
    ds_read_b128 v[156:159], v43 offset:0
    v_mfma_f32_16x16x32_bf16 v[100:103], v[164:167], v[140:143], v[100:103]
    ds_read_b128 v[160:163], v43 offset:4096
    v_mfma_f32_16x16x32_bf16 v[120:123], v[168:171], v[140:143], v[120:123]
    s_waitcnt lgkmcnt(4)
    s_add_u32 m0, s68, 24576
    v_mfma_f32_16x16x32_bf16 v[84:87], v[172:175], v[144:147], v[84:87]
    buffer_load_dwordx4 v19, s[28:31], s71 offen lds
    ds_read_b64_tr_b16 v[164:165], v52 offset:24576
    v_mfma_f32_16x16x32_bf16 v[104:107], v[176:179], v[144:147], v[104:107]
    ds_read_b64_tr_b16 v[166:167], v52 offset:25600
    s_waitcnt lgkmcnt(4)
    v_mfma_f32_16x16x32_bf16 v[88:91], v[172:175], v[148:151], v[88:91]
    ds_read_b128 v[124:127], v45 offset:53248
    s_add_u32 m0, s68, 28672
    v_mfma_f32_16x16x32_bf16 v[108:111], v[176:179], v[148:151], v[108:111]
    buffer_load_dwordx4 v20, s[28:31], s71 offen lds
    ds_read_b64_tr_b16 v[168:169], v55 offset:24576
    v_mfma_f32_16x16x32_bf16 v[92:95], v[172:175], v[152:155], v[92:95]
    ds_read_b64_tr_b16 v[170:171], v55 offset:25600
    v_mfma_f32_16x16x32_bf16 v[112:115], v[176:179], v[152:155], v[112:115]
    ds_read_b128 v[128:131], v45 offset:57344
    s_waitcnt lgkmcnt(6)
    s_add_u32 m0, s68, 32768
    v_mfma_f32_16x16x32_bf16 v[96:99], v[172:175], v[156:159], v[96:99]
    buffer_load_dwordx4 v21, s[28:31], s71 offen lds
    ds_read_b128 v[132:135], v45 offset:61440
    v_mfma_f32_16x16x32_bf16 v[116:119], v[176:179], v[156:159], v[116:119]
    ds_read_b128 v[136:139], v46 offset:0
    v_mfma_f32_16x16x32_bf16 v[100:103], v[172:175], v[160:163], v[100:103]
    ds_read_b128 v[140:143], v46 offset:4096
    s_add_u32 m0, s68, 36864
    v_mfma_f32_16x16x32_bf16 v[120:123], v[176:179], v[160:163], v[120:123]
    buffer_load_dwordx4 v22, s[28:31], s71 offen lds
    s_waitcnt lgkmcnt(4)
    v_mfma_f32_16x16x32_bf16 v[84:87], v[164:167], v[124:127], v[84:87]
    ds_read_b64_tr_b16 v[172:173], v52 offset:32768
    v_mfma_f32_16x16x32_bf16 v[104:107], v[168:171], v[124:127], v[104:107]
    ds_read_b64_tr_b16 v[174:175], v52 offset:33792
    s_waitcnt lgkmcnt(4)
    v_mfma_f32_16x16x32_bf16 v[88:91], v[164:167], v[128:131], v[88:91]
    ds_read_b128 v[144:147], v48 offset:53248
    s_add_u32 m0, s68, 40960
    v_mfma_f32_16x16x32_bf16 v[108:111], v[168:171], v[128:131], v[108:111]
    buffer_load_dwordx4 v23, s[28:31], s71 offen lds
    ds_read_b64_tr_b16 v[176:177], v55 offset:32768
    v_mfma_f32_16x16x32_bf16 v[92:95], v[164:167], v[132:135], v[92:95]
    ds_read_b64_tr_b16 v[178:179], v55 offset:33792
    v_mfma_f32_16x16x32_bf16 v[112:115], v[168:171], v[132:135], v[112:115]
    ds_read_b128 v[148:151], v48 offset:57344
    s_waitcnt lgkmcnt(6)
    s_add_u32 m0, s68, 45056
    v_mfma_f32_16x16x32_bf16 v[96:99], v[164:167], v[136:139], v[96:99]
    buffer_load_dwordx4 v24, s[28:31], s71 offen lds
    ds_read_b128 v[152:155], v48 offset:61440
    v_mfma_f32_16x16x32_bf16 v[116:119], v[168:171], v[136:139], v[116:119]
    ds_read_b128 v[156:159], v49 offset:0
    v_mfma_f32_16x16x32_bf16 v[100:103], v[164:167], v[140:143], v[100:103]
    ds_read_b128 v[160:163], v49 offset:4096
    s_add_u32 m0, s68, 49152
    v_mfma_f32_16x16x32_bf16 v[120:123], v[168:171], v[140:143], v[120:123]
    buffer_load_dwordx4 v25, s[28:31], s71 offen lds
    s_waitcnt vmcnt(13) lgkmcnt(0)
    s_barrier
    v_mfma_f32_16x16x32_bf16 v[84:87], v[172:175], v[144:147], v[84:87]
    s_add_u32 s3, s23, 4
    s_and_b32 s3, s3, 7
    s_lshl_b32 s70, s3, 8
    s_lshl_b32 s71, s3, 20
    s_add_u32 m0, s68, 53248
    s_nop 0
    buffer_load_dwordx4 v13, s[24:27], s70 offen lds
    ds_read_b64_tr_b16 v[164:165], v52 offset:61440
    v_mfma_f32_16x16x32_bf16 v[104:107], v[176:179], v[144:147], v[104:107]
    ds_read_b64_tr_b16 v[166:167], v52 offset:62464
    v_mfma_f32_16x16x32_bf16 v[88:91], v[172:175], v[148:151], v[88:91]
    ds_read_b128 v[124:127], v40 offset:40960
    s_add_u32 m0, s68, 57344
    v_mfma_f32_16x16x32_bf16 v[108:111], v[176:179], v[148:151], v[108:111]
    buffer_load_dwordx4 v14, s[24:27], s70 offen lds
    ds_read_b64_tr_b16 v[168:169], v55 offset:61440
    v_mfma_f32_16x16x32_bf16 v[92:95], v[172:175], v[152:155], v[92:95]
    ds_read_b64_tr_b16 v[170:171], v55 offset:62464
    v_mfma_f32_16x16x32_bf16 v[112:115], v[176:179], v[152:155], v[112:115]
    ds_read_b128 v[128:131], v40 offset:45056
    v_mfma_f32_16x16x32_bf16 v[96:99], v[172:175], v[156:159], v[96:99]
    ds_read_b128 v[132:135], v40 offset:49152
    s_add_u32 m0, s68, 61440
    v_mfma_f32_16x16x32_bf16 v[116:119], v[176:179], v[156:159], v[116:119]
    buffer_load_dwordx4 v15, s[24:27], s70 offen lds
    ds_read_b128 v[136:139], v40 offset:53248
    v_mfma_f32_16x16x32_bf16 v[100:103], v[172:175], v[160:163], v[100:103]
    ds_read_b128 v[140:143], v40 offset:57344
    v_mfma_f32_16x16x32_bf16 v[120:123], v[176:179], v[160:163], v[120:123]
    s_waitcnt lgkmcnt(4)
    s_add_u32 m0, s68, 65536
    v_mfma_f32_16x16x32_bf16 v[84:87], v[164:167], v[124:127], v[84:87]
    buffer_load_dwordx4 v16, s[24:27], s70 offen lds
    ds_read_b64_tr_b16 v[172:173], v53 offset:4096
    v_mfma_f32_16x16x32_bf16 v[104:107], v[168:171], v[124:127], v[104:107]
    ds_read_b64_tr_b16 v[174:175], v53 offset:5120
    s_waitcnt lgkmcnt(4)
    v_mfma_f32_16x16x32_bf16 v[88:91], v[164:167], v[128:131], v[88:91]
    ds_read_b128 v[144:147], v43 offset:40960
    s_add_u32 m0, s68, 69632
    v_mfma_f32_16x16x32_bf16 v[108:111], v[168:171], v[128:131], v[108:111]
    buffer_load_dwordx4 v17, s[24:27], s70 offen lds
    ds_read_b64_tr_b16 v[176:177], v56 offset:4096
    v_mfma_f32_16x16x32_bf16 v[92:95], v[164:167], v[132:135], v[92:95]
    ds_read_b64_tr_b16 v[178:179], v56 offset:5120
    v_mfma_f32_16x16x32_bf16 v[112:115], v[168:171], v[132:135], v[112:115]
    ds_read_b128 v[148:151], v43 offset:45056
    s_waitcnt lgkmcnt(6)
    s_add_u32 m0, s68, 73728
    v_mfma_f32_16x16x32_bf16 v[96:99], v[164:167], v[136:139], v[96:99]
    buffer_load_dwordx4 v18, s[28:31], s71 offen lds
    ds_read_b128 v[152:155], v43 offset:49152
    v_mfma_f32_16x16x32_bf16 v[116:119], v[168:171], v[136:139], v[116:119]
    ds_read_b128 v[156:159], v43 offset:53248
    v_mfma_f32_16x16x32_bf16 v[100:103], v[164:167], v[140:143], v[100:103]
    ds_read_b128 v[160:163], v43 offset:57344
    v_mfma_f32_16x16x32_bf16 v[120:123], v[168:171], v[140:143], v[120:123]
    s_waitcnt lgkmcnt(4)
    s_add_u32 m0, s68, 77824
    v_mfma_f32_16x16x32_bf16 v[84:87], v[172:175], v[144:147], v[84:87]
    buffer_load_dwordx4 v19, s[28:31], s71 offen lds
    ds_read_b64_tr_b16 v[164:165], v53 offset:12288
    v_mfma_f32_16x16x32_bf16 v[104:107], v[176:179], v[144:147], v[104:107]
    ds_read_b64_tr_b16 v[166:167], v53 offset:13312
    s_waitcnt lgkmcnt(4)
    v_mfma_f32_16x16x32_bf16 v[88:91], v[172:175], v[148:151], v[88:91]
    ds_read_b128 v[124:127], v46 offset:40960
    s_add_u32 m0, s68, 81920
    v_mfma_f32_16x16x32_bf16 v[108:111], v[176:179], v[148:151], v[108:111]
    buffer_load_dwordx4 v20, s[28:31], s71 offen lds
    ds_read_b64_tr_b16 v[168:169], v56 offset:12288
    v_mfma_f32_16x16x32_bf16 v[92:95], v[172:175], v[152:155], v[92:95]
    ds_read_b64_tr_b16 v[170:171], v56 offset:13312
    v_mfma_f32_16x16x32_bf16 v[112:115], v[176:179], v[152:155], v[112:115]
    ds_read_b128 v[128:131], v46 offset:45056
    s_waitcnt lgkmcnt(6)
    s_add_u32 m0, s68, 86016
    v_mfma_f32_16x16x32_bf16 v[96:99], v[172:175], v[156:159], v[96:99]
    buffer_load_dwordx4 v21, s[28:31], s71 offen lds
    ds_read_b128 v[132:135], v46 offset:49152
    v_mfma_f32_16x16x32_bf16 v[116:119], v[176:179], v[156:159], v[116:119]
    ds_read_b128 v[136:139], v46 offset:53248
    v_mfma_f32_16x16x32_bf16 v[100:103], v[172:175], v[160:163], v[100:103]
    ds_read_b128 v[140:143], v46 offset:57344
    s_add_u32 m0, s68, 90112
    v_mfma_f32_16x16x32_bf16 v[120:123], v[176:179], v[160:163], v[120:123]
    buffer_load_dwordx4 v22, s[28:31], s71 offen lds
    s_waitcnt lgkmcnt(4)
    v_mfma_f32_16x16x32_bf16 v[84:87], v[164:167], v[124:127], v[84:87]
    ds_read_b64_tr_b16 v[172:173], v53 offset:20480
    v_mfma_f32_16x16x32_bf16 v[104:107], v[168:171], v[124:127], v[104:107]
    ds_read_b64_tr_b16 v[174:175], v53 offset:21504
    s_waitcnt lgkmcnt(4)
    v_mfma_f32_16x16x32_bf16 v[88:91], v[164:167], v[128:131], v[88:91]
    ds_read_b128 v[144:147], v49 offset:40960
    s_add_u32 m0, s68, 94208
    v_mfma_f32_16x16x32_bf16 v[108:111], v[168:171], v[128:131], v[108:111]
    buffer_load_dwordx4 v23, s[28:31], s71 offen lds
    ds_read_b64_tr_b16 v[176:177], v56 offset:20480
    v_mfma_f32_16x16x32_bf16 v[92:95], v[164:167], v[132:135], v[92:95]
    ds_read_b64_tr_b16 v[178:179], v56 offset:21504
    v_mfma_f32_16x16x32_bf16 v[112:115], v[168:171], v[132:135], v[112:115]
    ds_read_b128 v[148:151], v49 offset:45056
    s_waitcnt lgkmcnt(6)
    s_add_u32 m0, s68, 98304
    v_mfma_f32_16x16x32_bf16 v[96:99], v[164:167], v[136:139], v[96:99]
    buffer_load_dwordx4 v24, s[28:31], s71 offen lds
    ds_read_b128 v[152:155], v49 offset:49152
    v_mfma_f32_16x16x32_bf16 v[116:119], v[168:171], v[136:139], v[116:119]
    ds_read_b128 v[156:159], v49 offset:53248
    v_mfma_f32_16x16x32_bf16 v[100:103], v[164:167], v[140:143], v[100:103]
    ds_read_b128 v[160:163], v49 offset:57344
    s_add_u32 m0, s68, 102400
    v_mfma_f32_16x16x32_bf16 v[120:123], v[168:171], v[140:143], v[120:123]
    buffer_load_dwordx4 v25, s[28:31], s71 offen lds
    s_waitcnt vmcnt(13) lgkmcnt(0)
    s_barrier
    v_mfma_f32_16x16x32_bf16 v[84:87], v[172:175], v[144:147], v[84:87]
    s_add_u32 s3, s23, 5
    s_and_b32 s3, s3, 7
    s_lshl_b32 s70, s3, 8
    s_lshl_b32 s71, s3, 20
    s_add_u32 m0, s68, 106496
    s_nop 0
    buffer_load_dwordx4 v13, s[24:27], s70 offen lds
    ds_read_b64_tr_b16 v[164:165], v51 offset:20480
    v_mfma_f32_16x16x32_bf16 v[104:107], v[176:179], v[144:147], v[104:107]
    ds_read_b64_tr_b16 v[166:167], v51 offset:21504
    v_mfma_f32_16x16x32_bf16 v[88:91], v[172:175], v[148:151], v[88:91]
    ds_read_b128 v[124:127], v39 offset:0
    s_add_u32 m0, s68, 110592
    v_mfma_f32_16x16x32_bf16 v[108:111], v[176:179], v[148:151], v[108:111]
    buffer_load_dwordx4 v14, s[24:27], s70 offen lds
    ds_read_b64_tr_b16 v[168:169], v54 offset:20480
    v_mfma_f32_16x16x32_bf16 v[92:95], v[172:175], v[152:155], v[92:95]
    ds_read_b64_tr_b16 v[170:171], v54 offset:21504
    v_mfma_f32_16x16x32_bf16 v[112:115], v[176:179], v[152:155], v[112:115]
    ds_read_b128 v[128:131], v39 offset:4096
    v_mfma_f32_16x16x32_bf16 v[96:99], v[172:175], v[156:159], v[96:99]
    ds_read_b128 v[132:135], v39 offset:8192
    s_add_u32 m0, s68, 114688
    v_mfma_f32_16x16x32_bf16 v[116:119], v[176:179], v[156:159], v[116:119]
    buffer_load_dwordx4 v15, s[24:27], s70 offen lds
    ds_read_b128 v[136:139], v39 offset:12288
    v_mfma_f32_16x16x32_bf16 v[100:103], v[172:175], v[160:163], v[100:103]
    ds_read_b128 v[140:143], v39 offset:16384
    v_mfma_f32_16x16x32_bf16 v[120:123], v[176:179], v[160:163], v[120:123]
    s_waitcnt lgkmcnt(4)
    s_add_u32 m0, s68, 118784
    v_mfma_f32_16x16x32_bf16 v[84:87], v[164:167], v[124:127], v[84:87]
    buffer_load_dwordx4 v16, s[24:27], s70 offen lds
    ds_read_b64_tr_b16 v[172:173], v51 offset:28672
    v_mfma_f32_16x16x32_bf16 v[104:107], v[168:171], v[124:127], v[104:107]
    ds_read_b64_tr_b16 v[174:175], v51 offset:29696
    s_waitcnt lgkmcnt(4)
    v_mfma_f32_16x16x32_bf16 v[88:91], v[164:167], v[128:131], v[88:91]
    ds_read_b128 v[144:147], v42 offset:0
    s_add_u32 m0, s68, 122880
    v_mfma_f32_16x16x32_bf16 v[108:111], v[168:171], v[128:131], v[108:111]
    buffer_load_dwordx4 v17, s[24:27], s70 offen lds
    ds_read_b64_tr_b16 v[176:177], v54 offset:28672
    v_mfma_f32_16x16x32_bf16 v[92:95], v[164:167], v[132:135], v[92:95]
    ds_read_b64_tr_b16 v[178:179], v54 offset:29696
    v_mfma_f32_16x16x32_bf16 v[112:115], v[168:171], v[132:135], v[112:115]
    ds_read_b128 v[148:151], v42 offset:4096
    s_waitcnt lgkmcnt(6)
    s_add_u32 m0, s68, 126976
    v_mfma_f32_16x16x32_bf16 v[96:99], v[164:167], v[136:139], v[96:99]
    buffer_load_dwordx4 v18, s[28:31], s71 offen lds
    ds_read_b128 v[152:155], v42 offset:8192
    v_mfma_f32_16x16x32_bf16 v[116:119], v[168:171], v[136:139], v[116:119]
    ds_read_b128 v[156:159], v42 offset:12288
    v_mfma_f32_16x16x32_bf16 v[100:103], v[164:167], v[140:143], v[100:103]
    ds_read_b128 v[160:163], v42 offset:16384
    v_mfma_f32_16x16x32_bf16 v[120:123], v[168:171], v[140:143], v[120:123]
    s_waitcnt lgkmcnt(4)
    s_add_u32 m0, s68, 131072
    v_mfma_f32_16x16x32_bf16 v[84:87], v[172:175], v[144:147], v[84:87]
    buffer_load_dwordx4 v19, s[28:31], s71 offen lds
    ds_read_b64_tr_b16 v[164:165], v51 offset:36864
    v_mfma_f32_16x16x32_bf16 v[104:107], v[176:179], v[144:147], v[104:107]
    ds_read_b64_tr_b16 v[166:167], v51 offset:37888
    s_waitcnt lgkmcnt(4)
    v_mfma_f32_16x16x32_bf16 v[88:91], v[172:175], v[148:151], v[88:91]
    ds_read_b128 v[124:127], v45 offset:0
    s_add_u32 m0, s68, 135168
    v_mfma_f32_16x16x32_bf16 v[108:111], v[176:179], v[148:151], v[108:111]
    buffer_load_dwordx4 v20, s[28:31], s71 offen lds
    ds_read_b64_tr_b16 v[168:169], v54 offset:36864
    v_mfma_f32_16x16x32_bf16 v[92:95], v[172:175], v[152:155], v[92:95]
    ds_read_b64_tr_b16 v[170:171], v54 offset:37888
    v_mfma_f32_16x16x32_bf16 v[112:115], v[176:179], v[152:155], v[112:115]
    ds_read_b128 v[128:131], v45 offset:4096
    s_waitcnt lgkmcnt(6)
    s_add_u32 m0, s68, 139264
    v_mfma_f32_16x16x32_bf16 v[96:99], v[172:175], v[156:159], v[96:99]
    buffer_load_dwordx4 v21, s[28:31], s71 offen lds
    ds_read_b128 v[132:135], v45 offset:8192
    v_mfma_f32_16x16x32_bf16 v[116:119], v[176:179], v[156:159], v[116:119]
    ds_read_b128 v[136:139], v45 offset:12288
    v_mfma_f32_16x16x32_bf16 v[100:103], v[172:175], v[160:163], v[100:103]
    ds_read_b128 v[140:143], v45 offset:16384
    s_add_u32 m0, s68, 143360
    v_mfma_f32_16x16x32_bf16 v[120:123], v[176:179], v[160:163], v[120:123]
    buffer_load_dwordx4 v22, s[28:31], s71 offen lds
    s_waitcnt lgkmcnt(4)
    v_mfma_f32_16x16x32_bf16 v[84:87], v[164:167], v[124:127], v[84:87]
    ds_read_b64_tr_b16 v[172:173], v51 offset:45056
    v_mfma_f32_16x16x32_bf16 v[104:107], v[168:171], v[124:127], v[104:107]
    ds_read_b64_tr_b16 v[174:175], v51 offset:46080
    s_waitcnt lgkmcnt(4)
    v_mfma_f32_16x16x32_bf16 v[88:91], v[164:167], v[128:131], v[88:91]
    ds_read_b128 v[144:147], v48 offset:0
    s_add_u32 m0, s68, 147456
    v_mfma_f32_16x16x32_bf16 v[108:111], v[168:171], v[128:131], v[108:111]
    buffer_load_dwordx4 v23, s[28:31], s71 offen lds
    ds_read_b64_tr_b16 v[176:177], v54 offset:45056
    v_mfma_f32_16x16x32_bf16 v[92:95], v[164:167], v[132:135], v[92:95]
    ds_read_b64_tr_b16 v[178:179], v54 offset:46080
    v_mfma_f32_16x16x32_bf16 v[112:115], v[168:171], v[132:135], v[112:115]
    ds_read_b128 v[148:151], v48 offset:4096
    s_waitcnt lgkmcnt(6)
    s_add_u32 m0, s68, 151552
    v_mfma_f32_16x16x32_bf16 v[96:99], v[164:167], v[136:139], v[96:99]
    buffer_load_dwordx4 v24, s[28:31], s71 offen lds
    ds_read_b128 v[152:155], v48 offset:8192
    v_mfma_f32_16x16x32_bf16 v[116:119], v[168:171], v[136:139], v[116:119]
    ds_read_b128 v[156:159], v48 offset:12288
    v_mfma_f32_16x16x32_bf16 v[100:103], v[164:167], v[140:143], v[100:103]
    ds_read_b128 v[160:163], v48 offset:16384
    s_add_u32 m0, s68, 155648
    v_mfma_f32_16x16x32_bf16 v[120:123], v[168:171], v[140:143], v[120:123]
    buffer_load_dwordx4 v25, s[28:31], s71 offen lds
    s_waitcnt vmcnt(13) lgkmcnt(0)
    s_barrier
    v_mfma_f32_16x16x32_bf16 v[84:87], v[172:175], v[144:147], v[84:87]
    s_add_u32 s3, s23, 6
    s_and_b32 s3, s3, 7
    s_lshl_b32 s70, s3, 8
    s_lshl_b32 s71, s3, 20
    s_add_u32 m0, s68, 0
    s_nop 0
    buffer_load_dwordx4 v13, s[24:27], s70 offen lds
    ds_read_b64_tr_b16 v[164:165], v52 offset:8192
    v_mfma_f32_16x16x32_bf16 v[104:107], v[176:179], v[144:147], v[104:107]
    ds_read_b64_tr_b16 v[166:167], v52 offset:9216
    v_mfma_f32_16x16x32_bf16 v[88:91], v[172:175], v[148:151], v[88:91]
    ds_read_b128 v[124:127], v39 offset:53248
    s_add_u32 m0, s68, 4096
    v_mfma_f32_16x16x32_bf16 v[108:111], v[176:179], v[148:151], v[108:111]
    buffer_load_dwordx4 v14, s[24:27], s70 offen lds
    ds_read_b64_tr_b16 v[168:169], v55 offset:8192
    v_mfma_f32_16x16x32_bf16 v[92:95], v[172:175], v[152:155], v[92:95]
    ds_read_b64_tr_b16 v[170:171], v55 offset:9216
    v_mfma_f32_16x16x32_bf16 v[112:115], v[176:179], v[152:155], v[112:115]
    ds_read_b128 v[128:131], v39 offset:57344
    v_mfma_f32_16x16x32_bf16 v[96:99], v[172:175], v[156:159], v[96:99]
    ds_read_b128 v[132:135], v39 offset:61440
    s_add_u32 m0, s68, 8192
    v_mfma_f32_16x16x32_bf16 v[116:119], v[176:179], v[156:159], v[116:119]
    buffer_load_dwordx4 v15, s[24:27], s70 offen lds
    ds_read_b128 v[136:139], v40 offset:0
    v_mfma_f32_16x16x32_bf16 v[100:103], v[172:175], v[160:163], v[100:103]
    ds_read_b128 v[140:143], v40 offset:4096
    v_mfma_f32_16x16x32_bf16 v[120:123], v[176:179], v[160:163], v[120:123]
    s_waitcnt lgkmcnt(4)
    s_add_u32 m0, s68, 12288
    v_mfma_f32_16x16x32_bf16 v[84:87], v[164:167], v[124:127], v[84:87]
    buffer_load_dwordx4 v16, s[24:27], s70 offen lds
    ds_read_b64_tr_b16 v[172:173], v52 offset:16384
    v_mfma_f32_16x16x32_bf16 v[104:107], v[168:171], v[124:127], v[104:107]
    ds_read_b64_tr_b16 v[174:175], v52 offset:17408
    s_waitcnt lgkmcnt(4)
    v_mfma_f32_16x16x32_bf16 v[88:91], v[164:167], v[128:131], v[88:91]
    ds_read_b128 v[144:147], v42 offset:53248
    s_add_u32 m0, s68, 16384
    v_mfma_f32_16x16x32_bf16 v[108:111], v[168:171], v[128:131], v[108:111]
    buffer_load_dwordx4 v17, s[24:27], s70 offen lds
    ds_read_b64_tr_b16 v[176:177], v55 offset:16384
    v_mfma_f32_16x16x32_bf16 v[92:95], v[164:167], v[132:135], v[92:95]
    ds_read_b64_tr_b16 v[178:179], v55 offset:17408
    v_mfma_f32_16x16x32_bf16 v[112:115], v[168:171], v[132:135], v[112:115]
    ds_read_b128 v[148:151], v42 offset:57344
    s_waitcnt lgkmcnt(6)
    s_add_u32 m0, s68, 20480
    v_mfma_f32_16x16x32_bf16 v[96:99], v[164:167], v[136:139], v[96:99]
    buffer_load_dwordx4 v18, s[28:31], s71 offen lds
    ds_read_b128 v[152:155], v42 offset:61440
    v_mfma_f32_16x16x32_bf16 v[116:119], v[168:171], v[136:139], v[116:119]
    ds_read_b128 v[156:159], v43 offset:0
    v_mfma_f32_16x16x32_bf16 v[100:103], v[164:167], v[140:143], v[100:103]
    ds_read_b128 v[160:163], v43 offset:4096
    v_mfma_f32_16x16x32_bf16 v[120:123], v[168:171], v[140:143], v[120:123]
    s_waitcnt lgkmcnt(4)
    s_add_u32 m0, s68, 24576
    v_mfma_f32_16x16x32_bf16 v[84:87], v[172:175], v[144:147], v[84:87]
    buffer_load_dwordx4 v19, s[28:31], s71 offen lds
    ds_read_b64_tr_b16 v[164:165], v52 offset:24576
    v_mfma_f32_16x16x32_bf16 v[104:107], v[176:179], v[144:147], v[104:107]
    ds_read_b64_tr_b16 v[166:167], v52 offset:25600
    s_waitcnt lgkmcnt(4)
    v_mfma_f32_16x16x32_bf16 v[88:91], v[172:175], v[148:151], v[88:91]
    ds_read_b128 v[124:127], v45 offset:53248
    s_add_u32 m0, s68, 28672
    v_mfma_f32_16x16x32_bf16 v[108:111], v[176:179], v[148:151], v[108:111]
    buffer_load_dwordx4 v20, s[28:31], s71 offen lds
    ds_read_b64_tr_b16 v[168:169], v55 offset:24576
    v_mfma_f32_16x16x32_bf16 v[92:95], v[172:175], v[152:155], v[92:95]
    ds_read_b64_tr_b16 v[170:171], v55 offset:25600
    v_mfma_f32_16x16x32_bf16 v[112:115], v[176:179], v[152:155], v[112:115]
    ds_read_b128 v[128:131], v45 offset:57344
    s_waitcnt lgkmcnt(6)
    s_add_u32 m0, s68, 32768
    v_mfma_f32_16x16x32_bf16 v[96:99], v[172:175], v[156:159], v[96:99]
    buffer_load_dwordx4 v21, s[28:31], s71 offen lds
    ds_read_b128 v[132:135], v45 offset:61440
    v_mfma_f32_16x16x32_bf16 v[116:119], v[176:179], v[156:159], v[116:119]
    ds_read_b128 v[136:139], v46 offset:0
    v_mfma_f32_16x16x32_bf16 v[100:103], v[172:175], v[160:163], v[100:103]
    ds_read_b128 v[140:143], v46 offset:4096
    s_add_u32 m0, s68, 36864
    v_mfma_f32_16x16x32_bf16 v[120:123], v[176:179], v[160:163], v[120:123]
    buffer_load_dwordx4 v22, s[28:31], s71 offen lds
    s_waitcnt lgkmcnt(4)
    v_mfma_f32_16x16x32_bf16 v[84:87], v[164:167], v[124:127], v[84:87]
    ds_read_b64_tr_b16 v[172:173], v52 offset:32768
    v_mfma_f32_16x16x32_bf16 v[104:107], v[168:171], v[124:127], v[104:107]
    ds_read_b64_tr_b16 v[174:175], v52 offset:33792
    s_waitcnt lgkmcnt(4)
    v_mfma_f32_16x16x32_bf16 v[88:91], v[164:167], v[128:131], v[88:91]
    ds_read_b128 v[144:147], v48 offset:53248
    s_add_u32 m0, s68, 40960
    v_mfma_f32_16x16x32_bf16 v[108:111], v[168:171], v[128:131], v[108:111]
    buffer_load_dwordx4 v23, s[28:31], s71 offen lds
    ds_read_b64_tr_b16 v[176:177], v55 offset:32768
    v_mfma_f32_16x16x32_bf16 v[92:95], v[164:167], v[132:135], v[92:95]
    ds_read_b64_tr_b16 v[178:179], v55 offset:33792
    v_mfma_f32_16x16x32_bf16 v[112:115], v[168:171], v[132:135], v[112:115]
    ds_read_b128 v[148:151], v48 offset:57344
    s_waitcnt lgkmcnt(6)
    s_add_u32 m0, s68, 45056
    v_mfma_f32_16x16x32_bf16 v[96:99], v[164:167], v[136:139], v[96:99]
    buffer_load_dwordx4 v24, s[28:31], s71 offen lds
    ds_read_b128 v[152:155], v48 offset:61440
    v_mfma_f32_16x16x32_bf16 v[116:119], v[168:171], v[136:139], v[116:119]
    ds_read_b128 v[156:159], v49 offset:0
    v_mfma_f32_16x16x32_bf16 v[100:103], v[164:167], v[140:143], v[100:103]
    ds_read_b128 v[160:163], v49 offset:4096
    s_add_u32 m0, s68, 49152
    v_mfma_f32_16x16x32_bf16 v[120:123], v[168:171], v[140:143], v[120:123]
    buffer_load_dwordx4 v25, s[28:31], s71 offen lds
    s_waitcnt vmcnt(13) lgkmcnt(0)
    s_barrier
    v_mfma_f32_16x16x32_bf16 v[84:87], v[172:175], v[144:147], v[84:87]
    s_add_u32 s3, s23, 7
    s_and_b32 s3, s3, 7
    s_lshl_b32 s70, s3, 8
    s_lshl_b32 s71, s3, 20
    s_add_u32 m0, s68, 53248
    s_nop 0
    buffer_load_dwordx4 v13, s[24:27], s70 offen lds
    ds_read_b64_tr_b16 v[164:165], v52 offset:61440
    v_mfma_f32_16x16x32_bf16 v[104:107], v[176:179], v[144:147], v[104:107]
    ds_read_b64_tr_b16 v[166:167], v52 offset:62464
    v_mfma_f32_16x16x32_bf16 v[88:91], v[172:175], v[148:151], v[88:91]
    ds_read_b128 v[124:127], v40 offset:40960
    s_add_u32 m0, s68, 57344
    v_mfma_f32_16x16x32_bf16 v[108:111], v[176:179], v[148:151], v[108:111]
    buffer_load_dwordx4 v14, s[24:27], s70 offen lds
    ds_read_b64_tr_b16 v[168:169], v55 offset:61440
    v_mfma_f32_16x16x32_bf16 v[92:95], v[172:175], v[152:155], v[92:95]
    ds_read_b64_tr_b16 v[170:171], v55 offset:62464
    v_mfma_f32_16x16x32_bf16 v[112:115], v[176:179], v[152:155], v[112:115]
    ds_read_b128 v[128:131], v40 offset:45056
    v_mfma_f32_16x16x32_bf16 v[96:99], v[172:175], v[156:159], v[96:99]
    ds_read_b128 v[132:135], v40 offset:49152
    s_add_u32 m0, s68, 61440
    v_mfma_f32_16x16x32_bf16 v[116:119], v[176:179], v[156:159], v[116:119]
    buffer_load_dwordx4 v15, s[24:27], s70 offen lds
    ds_read_b128 v[136:139], v40 offset:53248
    v_mfma_f32_16x16x32_bf16 v[100:103], v[172:175], v[160:163], v[100:103]
    ds_read_b128 v[140:143], v40 offset:57344
    v_mfma_f32_16x16x32_bf16 v[120:123], v[176:179], v[160:163], v[120:123]
    s_waitcnt lgkmcnt(4)
    s_add_u32 m0, s68, 65536
    v_mfma_f32_16x16x32_bf16 v[84:87], v[164:167], v[124:127], v[84:87]
    buffer_load_dwordx4 v16, s[24:27], s70 offen lds
    ds_read_b64_tr_b16 v[172:173], v53 offset:4096
    v_mfma_f32_16x16x32_bf16 v[104:107], v[168:171], v[124:127], v[104:107]
    ds_read_b64_tr_b16 v[174:175], v53 offset:5120
    s_waitcnt lgkmcnt(4)
    v_mfma_f32_16x16x32_bf16 v[88:91], v[164:167], v[128:131], v[88:91]
    ds_read_b128 v[144:147], v43 offset:40960
    s_add_u32 m0, s68, 69632
    v_mfma_f32_16x16x32_bf16 v[108:111], v[168:171], v[128:131], v[108:111]
    buffer_load_dwordx4 v17, s[24:27], s70 offen lds
    ds_read_b64_tr_b16 v[176:177], v56 offset:4096
    v_mfma_f32_16x16x32_bf16 v[92:95], v[164:167], v[132:135], v[92:95]
    ds_read_b64_tr_b16 v[178:179], v56 offset:5120
    v_mfma_f32_16x16x32_bf16 v[112:115], v[168:171], v[132:135], v[112:115]
    ds_read_b128 v[148:151], v43 offset:45056
    s_waitcnt lgkmcnt(6)
    s_add_u32 m0, s68, 73728
    v_mfma_f32_16x16x32_bf16 v[96:99], v[164:167], v[136:139], v[96:99]
    buffer_load_dwordx4 v18, s[28:31], s71 offen lds
    ds_read_b128 v[152:155], v43 offset:49152
    v_mfma_f32_16x16x32_bf16 v[116:119], v[168:171], v[136:139], v[116:119]
    ds_read_b128 v[156:159], v43 offset:53248
    v_mfma_f32_16x16x32_bf16 v[100:103], v[164:167], v[140:143], v[100:103]
    ds_read_b128 v[160:163], v43 offset:57344
    v_mfma_f32_16x16x32_bf16 v[120:123], v[168:171], v[140:143], v[120:123]
    s_waitcnt lgkmcnt(4)
    s_add_u32 m0, s68, 77824
    v_mfma_f32_16x16x32_bf16 v[84:87], v[172:175], v[144:147], v[84:87]
    buffer_load_dwordx4 v19, s[28:31], s71 offen lds
    ds_read_b64_tr_b16 v[164:165], v53 offset:12288
    v_mfma_f32_16x16x32_bf16 v[104:107], v[176:179], v[144:147], v[104:107]
    ds_read_b64_tr_b16 v[166:167], v53 offset:13312
    s_waitcnt lgkmcnt(4)
    v_mfma_f32_16x16x32_bf16 v[88:91], v[172:175], v[148:151], v[88:91]
    ds_read_b128 v[124:127], v46 offset:40960
    s_add_u32 m0, s68, 81920
    v_mfma_f32_16x16x32_bf16 v[108:111], v[176:179], v[148:151], v[108:111]
    buffer_load_dwordx4 v20, s[28:31], s71 offen lds
    ds_read_b64_tr_b16 v[168:169], v56 offset:12288
    v_mfma_f32_16x16x32_bf16 v[92:95], v[172:175], v[152:155], v[92:95]
    ds_read_b64_tr_b16 v[170:171], v56 offset:13312
    v_mfma_f32_16x16x32_bf16 v[112:115], v[176:179], v[152:155], v[112:115]
    ds_read_b128 v[128:131], v46 offset:45056
    s_waitcnt lgkmcnt(6)
    s_add_u32 m0, s68, 86016
    v_mfma_f32_16x16x32_bf16 v[96:99], v[172:175], v[156:159], v[96:99]
    buffer_load_dwordx4 v21, s[28:31], s71 offen lds
    ds_read_b128 v[132:135], v46 offset:49152
    v_mfma_f32_16x16x32_bf16 v[116:119], v[176:179], v[156:159], v[116:119]
    ds_read_b128 v[136:139], v46 offset:53248
    v_mfma_f32_16x16x32_bf16 v[100:103], v[172:175], v[160:163], v[100:103]
    ds_read_b128 v[140:143], v46 offset:57344
    s_add_u32 m0, s68, 90112
    v_mfma_f32_16x16x32_bf16 v[120:123], v[176:179], v[160:163], v[120:123]
    buffer_load_dwordx4 v22, s[28:31], s71 offen lds
    s_waitcnt lgkmcnt(4)
    v_mfma_f32_16x16x32_bf16 v[84:87], v[164:167], v[124:127], v[84:87]
    ds_read_b64_tr_b16 v[172:173], v53 offset:20480
    v_mfma_f32_16x16x32_bf16 v[104:107], v[168:171], v[124:127], v[104:107]
    ds_read_b64_tr_b16 v[174:175], v53 offset:21504
    s_waitcnt lgkmcnt(4)
    v_mfma_f32_16x16x32_bf16 v[88:91], v[164:167], v[128:131], v[88:91]
    ds_read_b128 v[144:147], v49 offset:40960
    s_add_u32 m0, s68, 94208
    v_mfma_f32_16x16x32_bf16 v[108:111], v[168:171], v[128:131], v[108:111]
    buffer_load_dwordx4 v23, s[28:31], s71 offen lds
    ds_read_b64_tr_b16 v[176:177], v56 offset:20480
    v_mfma_f32_16x16x32_bf16 v[92:95], v[164:167], v[132:135], v[92:95]
    ds_read_b64_tr_b16 v[178:179], v56 offset:21504
    v_mfma_f32_16x16x32_bf16 v[112:115], v[168:171], v[132:135], v[112:115]
    ds_read_b128 v[148:151], v49 offset:45056
    s_waitcnt lgkmcnt(6)
    s_add_u32 m0, s68, 98304
    v_mfma_f32_16x16x32_bf16 v[96:99], v[164:167], v[136:139], v[96:99]
    buffer_load_dwordx4 v24, s[28:31], s71 offen lds
    ds_read_b128 v[152:155], v49 offset:49152
    v_mfma_f32_16x16x32_bf16 v[116:119], v[168:171], v[136:139], v[116:119]
    ds_read_b128 v[156:159], v49 offset:53248
    v_mfma_f32_16x16x32_bf16 v[100:103], v[164:167], v[140:143], v[100:103]
    ds_read_b128 v[160:163], v49 offset:57344
    s_add_u32 m0, s68, 102400
    v_mfma_f32_16x16x32_bf16 v[120:123], v[168:171], v[140:143], v[120:123]
    buffer_load_dwordx4 v25, s[28:31], s71 offen lds
    s_waitcnt vmcnt(13) lgkmcnt(0)
    s_barrier
    v_mfma_f32_16x16x32_bf16 v[84:87], v[172:175], v[144:147], v[84:87]
    ds_read_b64_tr_b16 v[164:165], v51 offset:20480
    s_add_u32 m0, s68, 106496
    v_mfma_f32_16x16x32_bf16 v[104:107], v[176:179], v[144:147], v[104:107]
    buffer_load_dwordx4 v26, s[32:35], s72 offen nt lds
    ds_read_b64_tr_b16 v[166:167], v51 offset:21504
    v_mfma_f32_16x16x32_bf16 v[88:91], v[172:175], v[148:151], v[88:91]
    ds_read_b128 v[124:127], v39 offset:0
    v_mfma_f32_16x16x32_bf16 v[108:111], v[176:179], v[148:151], v[108:111]
    s_add_u32 m0, s68, 110592
    ds_read_b64_tr_b16 v[168:169], v54 offset:20480
    buffer_load_dwordx4 v26, s[32:35], s73 offen nt lds
    v_mfma_f32_16x16x32_bf16 v[92:95], v[172:175], v[152:155], v[92:95]
    ds_read_b64_tr_b16 v[170:171], v54 offset:21504
    v_mfma_f32_16x16x32_bf16 v[112:115], v[176:179], v[152:155], v[112:115]
    ds_read_b128 v[128:131], v39 offset:4096
    v_mfma_f32_16x16x32_bf16 v[96:99], v[172:175], v[156:159], v[96:99]
    s_add_u32 m0, s68, 114688
    ds_read_b128 v[132:135], v39 offset:8192
    buffer_load_dwordx4 v26, s[32:35], s74 offen nt lds
    v_mfma_f32_16x16x32_bf16 v[116:119], v[176:179], v[156:159], v[116:119]
    ds_read_b128 v[136:139], v39 offset:12288
    v_mfma_f32_16x16x32_bf16 v[100:103], v[172:175], v[160:163], v[100:103]
    ds_read_b128 v[140:143], v39 offset:16384
    v_mfma_f32_16x16x32_bf16 v[120:123], v[176:179], v[160:163], v[120:123]
    s_waitcnt lgkmcnt(4)
    v_mfma_f32_16x16x32_bf16 v[84:87], v[164:167], v[124:127], v[84:87]
    ds_read_b64_tr_b16 v[172:173], v51 offset:28672
    s_add_u32 m0, s68, 118784
    v_mfma_f32_16x16x32_bf16 v[104:107], v[168:171], v[124:127], v[104:107]
    buffer_load_dwordx4 v26, s[32:35], s75 offen nt lds
    ds_read_b64_tr_b16 v[174:175], v51 offset:29696
    s_waitcnt lgkmcnt(4)
    v_mfma_f32_16x16x32_bf16 v[88:91], v[164:167], v[128:131], v[88:91]
    ds_read_b128 v[144:147], v42 offset:0
    v_mfma_f32_16x16x32_bf16 v[108:111], v[168:171], v[128:131], v[108:111]
    ds_read_b64_tr_b16 v[176:177], v54 offset:28672
    v_mfma_f32_16x16x32_bf16 v[92:95], v[164:167], v[132:135], v[92:95]
    ds_read_b64_tr_b16 v[178:179], v54 offset:29696
    s_add_u32 m0, s68, 122880
    v_mfma_f32_16x16x32_bf16 v[112:115], v[168:171], v[132:135], v[112:115]
    buffer_load_dwordx4 v26, s[32:35], s76 offen nt lds
    ds_read_b128 v[148:151], v42 offset:4096
    s_waitcnt lgkmcnt(6)
    v_mfma_f32_16x16x32_bf16 v[96:99], v[164:167], v[136:139], v[96:99]
    ds_read_b128 v[152:155], v42 offset:8192
    v_mfma_f32_16x16x32_bf16 v[116:119], v[168:171], v[136:139], v[116:119]
    ds_read_b128 v[156:159], v42 offset:12288
    v_mfma_f32_16x16x32_bf16 v[100:103], v[164:167], v[140:143], v[100:103]
    ds_read_b128 v[160:163], v42 offset:16384
    v_mfma_f32_16x16x32_bf16 v[120:123], v[168:171], v[140:143], v[120:123]
    s_waitcnt lgkmcnt(4)
    v_mfma_f32_16x16x32_bf16 v[84:87], v[172:175], v[144:147], v[84:87]
    ds_read_b64_tr_b16 v[164:165], v51 offset:36864
    v_mfma_f32_16x16x32_bf16 v[104:107], v[176:179], v[144:147], v[104:107]
    ds_read_b64_tr_b16 v[166:167], v51 offset:37888
    s_waitcnt lgkmcnt(4)
    v_mfma_f32_16x16x32_bf16 v[88:91], v[172:175], v[148:151], v[88:91]
    ds_read_b128 v[124:127], v45 offset:0
    v_mfma_f32_16x16x32_bf16 v[108:111], v[176:179], v[148:151], v[108:111]
    ds_read_b64_tr_b16 v[168:169], v54 offset:36864
    v_mfma_f32_16x16x32_bf16 v[92:95], v[172:175], v[152:155], v[92:95]
    ds_read_b64_tr_b16 v[170:171], v54 offset:37888
    v_mfma_f32_16x16x32_bf16 v[112:115], v[176:179], v[152:155], v[112:115]
    ds_read_b128 v[128:131], v45 offset:4096
    s_waitcnt lgkmcnt(6)
    v_mfma_f32_16x16x32_bf16 v[96:99], v[172:175], v[156:159], v[96:99]
    ds_read_b128 v[132:135], v45 offset:8192
    v_mfma_f32_16x16x32_bf16 v[116:119], v[176:179], v[156:159], v[116:119]
    ds_read_b128 v[136:139], v45 offset:12288
    v_mfma_f32_16x16x32_bf16 v[100:103], v[172:175], v[160:163], v[100:103]
    ds_read_b128 v[140:143], v45 offset:16384
    v_mfma_f32_16x16x32_bf16 v[120:123], v[176:179], v[160:163], v[120:123]
    s_waitcnt lgkmcnt(4)
    v_mfma_f32_16x16x32_bf16 v[84:87], v[164:167], v[124:127], v[84:87]
    ds_read_b64_tr_b16 v[172:173], v51 offset:45056
    v_mfma_f32_16x16x32_bf16 v[104:107], v[168:171], v[124:127], v[104:107]
    ds_read_b64_tr_b16 v[174:175], v51 offset:46080
    s_waitcnt lgkmcnt(4)
    v_mfma_f32_16x16x32_bf16 v[88:91], v[164:167], v[128:131], v[88:91]
    ds_read_b128 v[144:147], v48 offset:0
    v_mfma_f32_16x16x32_bf16 v[108:111], v[168:171], v[128:131], v[108:111]
    ds_read_b64_tr_b16 v[176:177], v54 offset:45056
    v_mfma_f32_16x16x32_bf16 v[92:95], v[164:167], v[132:135], v[92:95]
    ds_read_b64_tr_b16 v[178:179], v54 offset:46080
    v_mfma_f32_16x16x32_bf16 v[112:115], v[168:171], v[132:135], v[112:115]
    ds_read_b128 v[148:151], v48 offset:4096
    s_waitcnt lgkmcnt(6)
    v_mfma_f32_16x16x32_bf16 v[96:99], v[164:167], v[136:139], v[96:99]
    ds_read_b128 v[152:155], v48 offset:8192
    v_mfma_f32_16x16x32_bf16 v[116:119], v[168:171], v[136:139], v[116:119]
    ds_read_b128 v[156:159], v48 offset:12288
    v_mfma_f32_16x16x32_bf16 v[100:103], v[164:167], v[140:143], v[100:103]
    ds_read_b128 v[160:163], v48 offset:16384
    v_mfma_f32_16x16x32_bf16 v[120:123], v[168:171], v[140:143], v[120:123]
    s_waitcnt vmcnt(5) lgkmcnt(0)
    s_barrier
    v_mfma_f32_16x16x32_bf16 v[84:87], v[172:175], v[144:147], v[84:87]
    ds_read_b64_tr_b16 v[164:165], v52 offset:8192
    s_add_u32 m0, s68, 126976
    v_mfma_f32_16x16x32_bf16 v[104:107], v[176:179], v[144:147], v[104:107]
    buffer_load_dwordx4 v27, s[36:39], s72 offen nt lds
    ds_read_b64_tr_b16 v[166:167], v52 offset:9216
    v_mfma_f32_16x16x32_bf16 v[88:91], v[172:175], v[148:151], v[88:91]
    ds_read_b128 v[124:127], v39 offset:53248
    v_mfma_f32_16x16x32_bf16 v[108:111], v[176:179], v[148:151], v[108:111]
    ds_read_b64_tr_b16 v[168:169], v55 offset:8192
    v_mfma_f32_16x16x32_bf16 v[92:95], v[172:175], v[152:155], v[92:95]
    ds_read_b64_tr_b16 v[170:171], v55 offset:9216
    v_mfma_f32_16x16x32_bf16 v[112:115], v[176:179], v[152:155], v[112:115]
    ds_read_b128 v[128:131], v39 offset:57344
    v_mfma_f32_16x16x32_bf16 v[96:99], v[172:175], v[156:159], v[96:99]
    ds_read_b128 v[132:135], v39 offset:61440
    v_mfma_f32_16x16x32_bf16 v[116:119], v[176:179], v[156:159], v[116:119]
    ds_read_b128 v[136:139], v40 offset:0
    v_mfma_f32_16x16x32_bf16 v[100:103], v[172:175], v[160:163], v[100:103]
    ds_read_b128 v[140:143], v40 offset:4096
    v_mfma_f32_16x16x32_bf16 v[120:123], v[176:179], v[160:163], v[120:123]
    s_waitcnt lgkmcnt(4)
    v_mfma_f32_16x16x32_bf16 v[84:87], v[164:167], v[124:127], v[84:87]
    ds_read_b64_tr_b16 v[172:173], v52 offset:16384
    s_add_u32 m0, s68, 131072
    v_mfma_f32_16x16x32_bf16 v[104:107], v[168:171], v[124:127], v[104:107]
    buffer_load_dwordx4 v27, s[36:39], s73 offen nt lds
    ds_read_b64_tr_b16 v[174:175], v52 offset:17408
    s_waitcnt lgkmcnt(4)
    v_mfma_f32_16x16x32_bf16 v[88:91], v[164:167], v[128:131], v[88:91]
    ds_read_b128 v[144:147], v42 offset:53248
    v_mfma_f32_16x16x32_bf16 v[108:111], v[168:171], v[128:131], v[108:111]
    ds_read_b64_tr_b16 v[176:177], v55 offset:16384
    v_mfma_f32_16x16x32_bf16 v[92:95], v[164:167], v[132:135], v[92:95]
    ds_read_b64_tr_b16 v[178:179], v55 offset:17408
    v_mfma_f32_16x16x32_bf16 v[112:115], v[168:171], v[132:135], v[112:115]
    ds_read_b128 v[148:151], v42 offset:57344
    s_waitcnt lgkmcnt(6)
    v_mfma_f32_16x16x32_bf16 v[96:99], v[164:167], v[136:139], v[96:99]
    ds_read_b128 v[152:155], v42 offset:61440
    v_mfma_f32_16x16x32_bf16 v[116:119], v[168:171], v[136:139], v[116:119]
    ds_read_b128 v[156:159], v43 offset:0
    v_mfma_f32_16x16x32_bf16 v[100:103], v[164:167], v[140:143], v[100:103]
    ds_read_b128 v[160:163], v43 offset:4096
    v_mfma_f32_16x16x32_bf16 v[120:123], v[168:171], v[140:143], v[120:123]
    s_waitcnt lgkmcnt(4)
    v_mfma_f32_16x16x32_bf16 v[84:87], v[172:175], v[144:147], v[84:87]
    ds_read_b64_tr_b16 v[164:165], v52 offset:24576
    s_add_u32 m0, s68, 135168
    v_mfma_f32_16x16x32_bf16 v[104:107], v[176:179], v[144:147], v[104:107]
    buffer_load_dwordx4 v27, s[36:39], s74 offen nt lds
    ds_read_b64_tr_b16 v[166:167], v52 offset:25600
    s_waitcnt lgkmcnt(4)
    v_mfma_f32_16x16x32_bf16 v[88:91], v[172:175], v[148:151], v[88:91]
    ds_read_b128 v[124:127], v45 offset:53248
    v_mfma_f32_16x16x32_bf16 v[108:111], v[176:179], v[148:151], v[108:111]
    ds_read_b64_tr_b16 v[168:169], v55 offset:24576
    v_mfma_f32_16x16x32_bf16 v[92:95], v[172:175], v[152:155], v[92:95]
    ds_read_b64_tr_b16 v[170:171], v55 offset:25600
    v_mfma_f32_16x16x32_bf16 v[112:115], v[176:179], v[152:155], v[112:115]
    ds_read_b128 v[128:131], v45 offset:57344
    s_waitcnt lgkmcnt(6)
    v_mfma_f32_16x16x32_bf16 v[96:99], v[172:175], v[156:159], v[96:99]
    ds_read_b128 v[132:135], v45 offset:61440
    v_mfma_f32_16x16x32_bf16 v[116:119], v[176:179], v[156:159], v[116:119]
    ds_read_b128 v[136:139], v46 offset:0
    v_mfma_f32_16x16x32_bf16 v[100:103], v[172:175], v[160:163], v[100:103]
    ds_read_b128 v[140:143], v46 offset:4096
    v_mfma_f32_16x16x32_bf16 v[120:123], v[176:179], v[160:163], v[120:123]
    s_waitcnt lgkmcnt(4)
    v_mfma_f32_16x16x32_bf16 v[84:87], v[164:167], v[124:127], v[84:87]
    ds_read_b64_tr_b16 v[172:173], v52 offset:32768
    s_add_u32 m0, s68, 139264
    v_mfma_f32_16x16x32_bf16 v[104:107], v[168:171], v[124:127], v[104:107]
    buffer_load_dwordx4 v27, s[36:39], s75 offen nt lds
    ds_read_b64_tr_b16 v[174:175], v52 offset:33792
    s_waitcnt lgkmcnt(4)
    v_mfma_f32_16x16x32_bf16 v[88:91], v[164:167], v[128:131], v[88:91]
    ds_read_b128 v[144:147], v48 offset:53248
    v_mfma_f32_16x16x32_bf16 v[108:111], v[168:171], v[128:131], v[108:111]
    ds_read_b64_tr_b16 v[176:177], v55 offset:32768
    v_mfma_f32_16x16x32_bf16 v[92:95], v[164:167], v[132:135], v[92:95]
    ds_read_b64_tr_b16 v[178:179], v55 offset:33792
    s_add_u32 m0, s68, 143360
    v_mfma_f32_16x16x32_bf16 v[112:115], v[168:171], v[132:135], v[112:115]
    buffer_load_dwordx4 v27, s[36:39], s76 offen nt lds
    ds_read_b128 v[148:151], v48 offset:57344
    s_waitcnt lgkmcnt(6)
    v_mfma_f32_16x16x32_bf16 v[96:99], v[164:167], v[136:139], v[96:99]
    ds_read_b128 v[152:155], v48 offset:61440
    v_mfma_f32_16x16x32_bf16 v[116:119], v[168:171], v[136:139], v[116:119]
    ds_read_b128 v[156:159], v49 offset:0
    v_mfma_f32_16x16x32_bf16 v[100:103], v[164:167], v[140:143], v[100:103]
    ds_read_b128 v[160:163], v49 offset:4096
    v_mfma_f32_16x16x32_bf16 v[120:123], v[168:171], v[140:143], v[120:123]
    s_waitcnt lgkmcnt(4)
    v_mfma_f32_16x16x32_bf16 v[84:87], v[172:175], v[144:147], v[84:87]
    v_mfma_f32_16x16x32_bf16 v[104:107], v[176:179], v[144:147], v[104:107]
    s_waitcnt lgkmcnt(2)
    v_mfma_f32_16x16x32_bf16 v[88:91], v[172:175], v[148:151], v[88:91]
    v_mfma_f32_16x16x32_bf16 v[108:111], v[176:179], v[148:151], v[108:111]
    v_mfma_f32_16x16x32_bf16 v[92:95], v[172:175], v[152:155], v[92:95]
    v_add_u32 v26, 1, v30
    s_mov_b32 s3, 0x9e3779b1
    v_mfma_f32_16x16x32_bf16 v[112:115], v[176:179], v[152:155], v[112:115]
    v_mul_lo_u32 v30, v26, s3
    s_waitcnt lgkmcnt(0)
    v_mfma_f32_16x16x32_bf16 v[96:99], v[172:175], v[156:159], v[96:99]
    v_cvt_pk_bf16_f32 v184, v84, v85
    v_cvt_pk_bf16_f32 v185, v86, v87
    v_mfma_f32_16x16x32_bf16 v[116:119], v[176:179], v[156:159], v[116:119]
    v_cvt_pk_bf16_f32 v186, v104, v105
    v_cvt_pk_bf16_f32 v187, v106, v107
    v_mfma_f32_16x16x32_bf16 v[100:103], v[172:175], v[160:163], v[100:103]
    ds_write_b128 v74, v[184:187] offset:32768
    v_cvt_pk_bf16_f32 v188, v88, v89
    v_mfma_f32_16x16x32_bf16 v[120:123], v[176:179], v[160:163], v[120:123]
    v_cvt_pk_bf16_f32 v189, v90, v91
    v_cvt_pk_bf16_f32 v190, v108, v109
    v_cvt_pk_bf16_f32 v191, v110, v111
    ds_write_b128 v74, v[188:191] offset:36864
    v_cvt_pk_bf16_f32 v192, v92, v93
    v_cvt_pk_bf16_f32 v193, v94, v95
    v_cvt_pk_bf16_f32 v194, v112, v113
    v_cvt_pk_bf16_f32 v195, v114, v115
    ds_write_b128 v74, v[192:195] offset:40960
    v_cvt_pk_bf16_f32 v196, v96, v97
    v_cvt_pk_bf16_f32 v197, v98, v99
    v_cvt_pk_bf16_f32 v198, v116, v117
    v_cvt_pk_bf16_f32 v199, v118, v119
    ds_write_b128 v74, v[196:199] offset:45056
    v_cvt_pk_bf16_f32 v200, v100, v101
    v_cvt_pk_bf16_f32 v201, v102, v103
    v_cvt_pk_bf16_f32 v202, v120, v121
    v_cvt_pk_bf16_f32 v203, v122, v123
    ds_write_b128 v74, v[200:203] offset:49152
    s_waitcnt vmcnt(5) lgkmcnt(0)
    s_barrier
    ds_read_b128 v[124:127], v73 offset:32768
    ds_read_b64 a[96:97], v57 offset:0
    ds_read_b64 a[98:99], v58 offset:0
    ds_read_b64 a[112:113], v57 offset:4096
    ds_read_b64 a[114:115], v58 offset:4096
    ds_read_b64 a[128:129], v57 offset:8192
    ds_read_b64 a[130:131], v58 offset:8192
    ds_read_b64 a[144:145], v57 offset:12288
    ds_read_b64 a[146:147], v58 offset:12288
    ds_read_b64 a[160:161], v57 offset:16384
    ds_read_b64 a[162:163], v58 offset:16384
    v_mov_b32 v200, 0x3f803f80
    v_mov_b32 v201, 0x3f803f80
    v_mov_b32 v202, 0x3f803f80
    v_mov_b32 v203, 0x3f803f80
    s_add_u32 s87, s78, s21
    s_and_b32 s87, s87, 7
    s_lshl_b32 s95, s87, 18
    s_add_u32 m0, s68, 0
    s_nop 0
    buffer_load_dwordx4 v31, s[44:47], s95 offen lds
    s_add_u32 m0, s68, 4096
    s_nop 0
    buffer_load_dwordx4 v32, s[44:47], s95 offen lds
    s_add_u32 m0, s68, 8192
    s_nop 0
    buffer_load_dwordx4 v33, s[44:47], s95 offen lds
    s_add_u32 m0, s68, 12288
    s_nop 0
    buffer_load_dwordx4 v34, s[44:47], s95 offen lds
    s_add_u32 m0, s68, 16384
    s_nop 0
    buffer_load_dwordx4 v35, s[44:47], s95 offen lds
    s_waitcnt lgkmcnt(8)
    v_mfma_f32_16x16x32_bf16 v[204:207], a[96:99], v[124:127], 0
    ds_read_b128 v[128:131], v73 offset:33792
    ds_read_b64 a[100:101], v59 offset:0
    s_waitcnt lgkmcnt(6)
    v_mfma_f32_16x16x32_bf16 v[208:211], a[112:115], v[124:127], 0
    ds_read_b64 a[102:103], v60 offset:0
    ds_read_b64 a[116:117], v59 offset:4096
    v_mfma_f32_16x16x32_bf16 v[212:215], a[128:131], v[124:127], 0
    ds_read_b64 a[118:119], v60 offset:4096
    ds_read_b64 a[132:133], v59 offset:8192
    s_waitcnt lgkmcnt(6)
    v_mfma_f32_16x16x32_bf16 v[216:219], a[144:147], v[124:127], 0
    ds_read_b64 a[134:135], v60 offset:8192
    ds_read_b64 a[148:149], v59 offset:12288
    v_mfma_f32_16x16x32_bf16 v[220:223], a[160:163], v[124:127], 0
    ds_read_b64 a[150:151], v60 offset:12288
    ds_read_b64 a[164:165], v59 offset:16384
    ds_read_b64 a[166:167], v60 offset:16384
    s_waitcnt lgkmcnt(8)
    v_mfma_f32_16x16x32_bf16 v[204:207], a[100:103], v[128:131], v[204:207]
    ds_read_b128 v[132:135], v73 offset:34816
    ds_read_b64 a[104:105], v61 offset:0
    s_waitcnt lgkmcnt(6)
    v_mfma_f32_16x16x32_bf16 v[208:211], a[116:119], v[128:131], v[208:211]
    ds_read_b64 a[106:107], v62 offset:0
    ds_read_b64 a[120:121], v61 offset:4096
    v_mfma_f32_16x16x32_bf16 v[212:215], a[132:135], v[128:131], v[212:215]
    ds_read_b64 a[122:123], v62 offset:4096
    ds_read_b64 a[136:137], v61 offset:8192
    s_waitcnt lgkmcnt(6)
    v_mfma_f32_16x16x32_bf16 v[216:219], a[148:151], v[128:131], v[216:219]
    ds_read_b64 a[138:139], v62 offset:8192
    ds_read_b64 a[152:153], v61 offset:12288
    v_mfma_f32_16x16x32_bf16 v[220:223], a[164:167], v[128:131], v[220:223]
    ds_read_b64 a[154:155], v62 offset:12288
    ds_read_b64 a[168:169], v61 offset:16384
    ds_read_b64 a[170:171], v62 offset:16384
    s_waitcnt lgkmcnt(8)
    v_mfma_f32_16x16x32_bf16 v[204:207], a[104:107], v[132:135], v[204:207]
    ds_read_b128 v[136:139], v73 offset:35840
    ds_read_b64 a[108:109], v63 offset:0
    s_waitcnt lgkmcnt(6)
    v_mfma_f32_16x16x32_bf16 v[208:211], a[120:123], v[132:135], v[208:211]
    ds_read_b64 a[110:111], v64 offset:0
    ds_read_b64 a[124:125], v63 offset:4096
    v_mfma_f32_16x16x32_bf16 v[212:215], a[136:139], v[132:135], v[212:215]
    ds_read_b64 a[126:127], v64 offset:4096
    ds_read_b64 a[140:141], v63 offset:8192
    s_waitcnt lgkmcnt(6)
    v_mfma_f32_16x16x32_bf16 v[216:219], a[152:155], v[132:135], v[216:219]
    ds_read_b64 a[142:143], v64 offset:8192
    ds_read_b64 a[156:157], v63 offset:12288
    v_mfma_f32_16x16x32_bf16 v[220:223], a[168:171], v[132:135], v[220:223]
    ds_read_b64 a[158:159], v64 offset:12288
    ds_read_b64 a[172:173], v63 offset:16384
    ds_read_b64 a[174:175], v64 offset:16384
    s_waitcnt lgkmcnt(8)
    v_mfma_f32_16x16x32_bf16 v[204:207], a[108:111], v[136:139], v[204:207]
    ds_read_b128 v[140:143], v7 offset:49152
    ds_read_b128 v[144:147], v7 offset:50176
    s_waitcnt lgkmcnt(6)
    v_mfma_f32_16x16x32_bf16 v[208:211], a[124:127], v[136:139], v[208:211]
    ds_read_b128 v[148:151], v7 offset:51200
    ds_read_b128 v[152:155], v7 offset:52224
    v_mfma_f32_16x16x32_bf16 v[212:215], a[140:143], v[136:139], v[212:215]
    s_waitcnt lgkmcnt(4)
    v_mfma_f32_16x16x32_bf16 v[216:219], a[156:159], v[136:139], v[216:219]
    v_mfma_f32_16x16x32_bf16 v[220:223], a[172:175], v[136:139], v[220:223]
    s_waitcnt lgkmcnt(3)
    v_mfma_f32_16x16x32_bf16 v[224:227], a[96:99], v[140:143], 0
    v_mfma_f32_16x16x32_bf16 v[228:231], a[112:115], v[140:143], 0
    v_mfma_f32_16x16x32_bf16 v[232:235], a[128:131], v[140:143], 0
    v_mfma_f32_16x16x32_bf16 v[236:239], a[144:147], v[140:143], 0
    v_max3_f32 v244, v204, v205, v206
    v_mfma_f32_16x16x32_bf16 v[240:243], a[160:163], v[140:143], 0
    v_max3_f32 v245, v207, v208, v209
    v_max3_f32 v244, v244, v210, v211
    s_waitcnt lgkmcnt(2)
    v_mfma_f32_16x16x32_bf16 v[224:227], a[100:103], v[144:147], v[224:227]
    v_max3_f32 v245, v245, v212, v213
    v_max3_f32 v244, v244, v214, v215
    v_max3_f32 v245, v245, v216, v217
    v_mfma_f32_16x16x32_bf16 v[228:231], a[116:119], v[144:147], v[228:231]
    v_max3_f32 v244, v244, v218, v219
    v_max3_f32 v245, v245, v220, v221
    v_max3_f32 v244, v244, v222, v223
    v_mfma_f32_16x16x32_bf16 v[232:235], a[132:135], v[144:147], v[232:235]
    v_max_f32 v244, v244, v245
    v_mov_b32 v245, v244
    s_nop 1
    v_permlane32_swap_b32 v244, v245
    v_mfma_f32_16x16x32_bf16 v[236:239], a[148:151], v[144:147], v[236:239]
    v_max_f32 v244, v244, v245
    v_mov_b32 v245, v244
    s_nop 1
    v_permlane16_swap_b32 v244, v245
    v_mfma_f32_16x16x32_bf16 v[240:243], a[164:167], v[144:147], v[240:243]
    v_max_f32 v244, v244, v245
    v_mul_f32 v246, s80, v244
    s_waitcnt lgkmcnt(1)
    v_mfma_f32_16x16x32_bf16 v[224:227], a[104:107], v[148:151], v[224:227]
    v_pk_fma_f32 v[204:205], v[204:205], s[80:81], v[246:247] op_sel_hi:[1,0,0] neg_lo:[0,0,1] neg_hi:[0,0,1]
    v_pk_fma_f32 v[206:207], v[206:207], s[80:81], v[246:247] op_sel_hi:[1,0,0] neg_lo:[0,0,1] neg_hi:[0,0,1]
    v_pk_fma_f32 v[208:209], v[208:209], s[80:81], v[246:247] op_sel_hi:[1,0,0] neg_lo:[0,0,1] neg_hi:[0,0,1]
    v_mfma_f32_16x16x32_bf16 v[228:231], a[120:123], v[148:151], v[228:231]
    v_pk_fma_f32 v[210:211], v[210:211], s[80:81], v[246:247] op_sel_hi:[1,0,0] neg_lo:[0,0,1] neg_hi:[0,0,1]
    v_pk_fma_f32 v[212:213], v[212:213], s[80:81], v[246:247] op_sel_hi:[1,0,0] neg_lo:[0,0,1] neg_hi:[0,0,1]
    s_add_u32 m0, s68, 20480
    v_pk_fma_f32 v[214:215], v[214:215], s[80:81], v[246:247] op_sel_hi:[1,0,0] neg_lo:[0,0,1] neg_hi:[0,0,1]
    buffer_load_dwordx4 v36, s[44:47], s95 offen lds
    v_mfma_f32_16x16x32_bf16 v[232:235], a[136:139], v[148:151], v[232:235]
    v_pk_fma_f32 v[216:217], v[216:217], s[80:81], v[246:247] op_sel_hi:[1,0,0] neg_lo:[0,0,1] neg_hi:[0,0,1]
    v_pk_fma_f32 v[218:219], v[218:219], s[80:81], v[246:247] op_sel_hi:[1,0,0] neg_lo:[0,0,1] neg_hi:[0,0,1]
    v_pk_fma_f32 v[220:221], v[220:221], s[80:81], v[246:247] op_sel_hi:[1,0,0] neg_lo:[0,0,1] neg_hi:[0,0,1]
    v_mfma_f32_16x16x32_bf16 v[236:239], a[152:155], v[148:151], v[236:239]
    v_pk_fma_f32 v[222:223], v[222:223], s[80:81], v[246:247] op_sel_hi:[1,0,0] neg_lo:[0,0,1] neg_hi:[0,0,1]
    v_exp_f32 v204, v204
    v_exp_f32 v205, v205
    v_mfma_f32_16x16x32_bf16 v[240:243], a[168:171], v[148:151], v[240:243]
    v_exp_f32 v206, v206
    v_exp_f32 v207, v207
    s_waitcnt lgkmcnt(0)
    v_mfma_f32_16x16x32_bf16 v[224:227], a[108:111], v[152:155], v[224:227]
    v_cvt_pk_bf16_f32 v164, v204, v205
    s_add_u32 m0, s68, 24576
    v_exp_f32 v208, v208
    buffer_load_dwordx4 v37, s[44:47], s95 offen lds
    v_exp_f32 v209, v209
    v_mfma_f32_16x16x32_bf16 v[228:231], a[124:127], v[152:155], v[228:231]
    v_cvt_pk_bf16_f32 v165, v206, v207
    v_exp_f32 v210, v210
    v_exp_f32 v211, v211
    v_mfma_f32_16x16x32_bf16 v[232:235], a[140:143], v[152:155], v[232:235]
    v_cvt_pk_bf16_f32 v166, v208, v209
    v_exp_f32 v212, v212
    v_exp_f32 v213, v213
    v_mfma_f32_16x16x32_bf16 v[236:239], a[156:159], v[152:155], v[236:239]
    v_cvt_pk_bf16_f32 v167, v210, v211
    v_exp_f32 v214, v214
    v_exp_f32 v215, v215
    s_add_u32 m0, s68, 28672
    v_mfma_f32_16x16x32_bf16 v[240:243], a[172:175], v[152:155], v[240:243]
    buffer_load_dwordx4 v38, s[44:47], s95 offen lds
    v_cvt_pk_bf16_f32 v168, v212, v213
    v_exp_f32 v216, v216
    v_exp_f32 v217, v217
    v_cvt_pk_bf16_f32 v169, v214, v215
    v_exp_f32 v218, v218
    v_exp_f32 v219, v219
    v_cvt_pk_bf16_f32 v170, v216, v217
    v_exp_f32 v220, v220
    v_exp_f32 v221, v221
    v_cvt_pk_bf16_f32 v171, v218, v219
    v_exp_f32 v222, v222
    v_exp_f32 v223, v223
    v_cvt_pk_bf16_f32 v172, v220, v221
    v_cvt_pk_bf16_f32 v173, v222, v223
    s_waitcnt vmcnt(8)
    s_barrier
    ds_read_b64_tr_b16 a[176:177], v65 offset:0
    ds_read_b64_tr_b16 a[178:179], v65 offset:4096
    ds_read_b64_tr_b16 a[186:187], v66 offset:0
    ds_read_b64_tr_b16 a[188:189], v66 offset:4096
    ds_read_b64_tr_b16 a[196:197], v67 offset:0
    ds_read_b64_tr_b16 a[198:199], v67 offset:4096
    ds_read_b64_tr_b16 a[206:207], v68 offset:0
    ds_read_b64_tr_b16 a[208:209], v68 offset:4096
    v_max3_f32 v244, v224, v225, v226
    ds_read_b64_tr_b16 a[216:217], v69 offset:0
    v_max3_f32 v245, v227, v228, v229
    ds_read_b64_tr_b16 a[218:219], v69 offset:4096
    v_max3_f32 v244, v244, v230, v231
    ds_read_b64_tr_b16 a[226:227], v70 offset:0
    v_max3_f32 v245, v245, v232, v233
    ds_read_b64_tr_b16 a[228:229], v70 offset:4096
    v_max3_f32 v244, v244, v234, v235
    ds_read_b64_tr_b16 a[236:237], v71 offset:0
    v_mfma_f32_16x16x32_bf16 v[156:159], v[200:203], v[164:167], 0
    ds_read_b64_tr_b16 a[238:239], v71 offset:4096
    v_max3_f32 v245, v245, v236, v237
    ds_read_b64_tr_b16 a[246:247], v72 offset:0
    s_waitcnt lgkmcnt(13)
    v_mfma_f32_16x16x32_bf16 v[84:87], a[176:179], v[164:167], 0
    ds_read_b64_tr_b16 a[248:249], v72 offset:4096
    v_max3_f32 v244, v244, v238, v239
    ds_read_b64_tr_b16 a[180:181], v65 offset:8192
    v_max3_f32 v245, v245, v240, v241
    s_waitcnt lgkmcnt(12)
    ds_read_b64_tr_b16 a[182:183], v65 offset:12288
    v_mfma_f32_16x16x32_bf16 v[88:91], a[186:189], v[164:167], 0
    ds_read_b64_tr_b16 a[190:191], v66 offset:8192
    v_max3_f32 v244, v244, v242, v243
    ds_read_b64_tr_b16 a[192:193], v66 offset:12288
    v_max_f32 v244, v244, v245
    s_waitcnt lgkmcnt(12)
    ds_read_b64_tr_b16 a[200:201], v67 offset:8192
    v_mfma_f32_16x16x32_bf16 v[92:95], a[196:199], v[164:167], 0
    ds_read_b64_tr_b16 a[202:203], v67 offset:12288
    v_mov_b32 v245, v244
    ds_read_b64_tr_b16 a[210:211], v68 offset:8192
    s_nop 0
    v_permlane32_swap_b32 v244, v245
    s_waitcnt lgkmcnt(12)
    ds_read_b64_tr_b16 a[212:213], v68 offset:12288
    v_mfma_f32_16x16x32_bf16 v[96:99], a[206:209], v[164:167], 0
    ds_read_b64_tr_b16 a[220:221], v69 offset:8192
    v_max_f32 v244, v244, v245
    ds_read_b64_tr_b16 a[222:223], v69 offset:12288
    v_mov_b32 v245, v244
    s_waitcnt lgkmcnt(12)
    ds_read_b64_tr_b16 a[230:231], v70 offset:8192
    v_mfma_f32_16x16x32_bf16 v[100:103], a[216:219], v[164:167], 0
    ds_read_b64_tr_b16 a[232:233], v70 offset:12288
    v_permlane16_swap_b32 v244, v245
    ds_read_b64_tr_b16 a[240:241], v71 offset:8192
    v_max_f32 v244, v244, v245
    s_waitcnt lgkmcnt(12)
    ds_read_b64_tr_b16 a[242:243], v71 offset:12288
    v_mfma_f32_16x16x32_bf16 v[104:107], a[226:229], v[164:167], 0
    ds_read_b64_tr_b16 a[250:251], v72 offset:8192
    v_mul_f32 v246, s80, v244
    ds_read_b64_tr_b16 a[252:253], v72 offset:12288
    v_pk_fma_f32 v[224:225], v[224:225], s[80:81], v[246:247] op_sel_hi:[1,0,0] neg_lo:[0,0,1] neg_hi:[0,0,1]
    s_waitcnt lgkmcnt(12)
    ds_read_b64_tr_b16 a[184:185], v65 offset:16384
    v_mfma_f32_16x16x32_bf16 v[108:111], a[236:239], v[164:167], 0
    ds_read_b64_tr_b16 a[194:195], v66 offset:16384
    v_pk_fma_f32 v[226:227], v[226:227], s[80:81], v[246:247] op_sel_hi:[1,0,0] neg_lo:[0,0,1] neg_hi:[0,0,1]
    ds_read_b64_tr_b16 a[204:205], v67 offset:16384
    v_pk_fma_f32 v[228:229], v[228:229], s[80:81], v[246:247] op_sel_hi:[1,0,0] neg_lo:[0,0,1] neg_hi:[0,0,1]
    s_waitcnt lgkmcnt(12)
    ds_read_b64_tr_b16 a[214:215], v68 offset:16384
    v_mfma_f32_16x16x32_bf16 v[112:115], a[246:249], v[164:167], 0
    ds_read_b64_tr_b16 a[224:225], v69 offset:16384
    v_pk_fma_f32 v[230:231], v[230:231], s[80:81], v[246:247] op_sel_hi:[1,0,0] neg_lo:[0,0,1] neg_hi:[0,0,1]
    ds_read_b64_tr_b16 a[234:235], v70 offset:16384
    v_pk_fma_f32 v[232:233], v[232:233], s[80:81], v[246:247] op_sel_hi:[1,0,0] neg_lo:[0,0,1] neg_hi:[0,0,1]
    s_waitcnt lgkmcnt(12)
    ds_read_b64_tr_b16 a[244:245], v71 offset:16384
    v_mfma_f32_16x16x32_bf16 v[156:159], v[200:203], v[168:171], v[156:159]
    ds_read_b64_tr_b16 a[254:255], v72 offset:16384
    v_pk_fma_f32 v[234:235], v[234:235], s[80:81], v[246:247] op_sel_hi:[1,0,0] neg_lo:[0,0,1] neg_hi:[0,0,1]
    v_pk_fma_f32 v[236:237], v[236:237], s[80:81], v[246:247] op_sel_hi:[1,0,0] neg_lo:[0,0,1] neg_hi:[0,0,1]
    v_mfma_f32_16x16x32_bf16 v[84:87], a[180:183], v[168:171], v[84:87]
    v_pk_fma_f32 v[238:239], v[238:239], s[80:81], v[246:247] op_sel_hi:[1,0,0] neg_lo:[0,0,1] neg_hi:[0,0,1]
    v_pk_fma_f32 v[240:241], v[240:241], s[80:81], v[246:247] op_sel_hi:[1,0,0] neg_lo:[0,0,1] neg_hi:[0,0,1]
    v_mfma_f32_16x16x32_bf16 v[88:91], a[190:193], v[168:171], v[88:91]
    v_pk_fma_f32 v[242:243], v[242:243], s[80:81], v[246:247] op_sel_hi:[1,0,0] neg_lo:[0,0,1] neg_hi:[0,0,1]
    v_exp_f32 v224, v224
    v_mfma_f32_16x16x32_bf16 v[92:95], a[200:203], v[168:171], v[92:95]
    v_exp_f32 v225, v225
    v_exp_f32 v226, v226
    v_mfma_f32_16x16x32_bf16 v[96:99], a[210:213], v[168:171], v[96:99]
    v_exp_f32 v227, v227
    v_cvt_pk_bf16_f32 v174, v224, v225
    v_mfma_f32_16x16x32_bf16 v[100:103], a[220:223], v[168:171], v[100:103]
    v_exp_f32 v228, v228
    v_exp_f32 v229, v229
    s_waitcnt lgkmcnt(12)
    v_mfma_f32_16x16x32_bf16 v[104:107], a[230:233], v[168:171], v[104:107]
    v_cvt_pk_bf16_f32 v175, v226, v227
    v_exp_f32 v230, v230
    s_waitcnt lgkmcnt(10)
    v_mfma_f32_16x16x32_bf16 v[108:111], a[240:243], v[168:171], v[108:111]
    v_exp_f32 v231, v231
    v_cvt_pk_bf16_f32 v176, v228, v229
    s_waitcnt lgkmcnt(8)
    v_mfma_f32_16x16x32_bf16 v[112:115], a[250:253], v[168:171], v[112:115]
    v_exp_f32 v232, v232
    v_exp_f32 v233, v233
    v_mfma_f32_16x16x16_bf16 v[156:159], v[200:201], v[172:173], v[156:159]
    v_cvt_pk_bf16_f32 v177, v230, v231
    v_exp_f32 v234, v234
    s_waitcnt lgkmcnt(7)
    v_mfma_f32_16x16x16_bf16 v[84:87], a[184:185], v[172:173], v[84:87]
    v_exp_f32 v235, v235
    v_cvt_pk_bf16_f32 v178, v232, v233
    s_waitcnt lgkmcnt(6)
    v_mfma_f32_16x16x16_bf16 v[88:91], a[194:195], v[172:173], v[88:91]
    v_exp_f32 v236, v236
    v_exp_f32 v237, v237
    s_waitcnt lgkmcnt(5)
    v_mfma_f32_16x16x16_bf16 v[92:95], a[204:205], v[172:173], v[92:95]
    v_cvt_pk_bf16_f32 v179, v234, v235
    v_exp_f32 v238, v238
    s_waitcnt lgkmcnt(4)
    v_mfma_f32_16x16x16_bf16 v[96:99], a[214:215], v[172:173], v[96:99]
    v_exp_f32 v239, v239
    v_cvt_pk_bf16_f32 v180, v236, v237
    s_waitcnt lgkmcnt(3)
    v_mfma_f32_16x16x16_bf16 v[100:103], a[224:225], v[172:173], v[100:103]
    v_exp_f32 v240, v240
    v_exp_f32 v241, v241
    s_waitcnt lgkmcnt(2)
    v_mfma_f32_16x16x16_bf16 v[104:107], a[234:235], v[172:173], v[104:107]
    v_cvt_pk_bf16_f32 v181, v238, v239
    v_exp_f32 v242, v242
    s_waitcnt lgkmcnt(1)
    v_mfma_f32_16x16x16_bf16 v[108:111], a[244:245], v[172:173], v[108:111]
    v_exp_f32 v243, v243
    v_cvt_pk_bf16_f32 v182, v240, v241
    s_waitcnt lgkmcnt(0)
    v_mfma_f32_16x16x16_bf16 v[112:115], a[254:255], v[172:173], v[112:115]
    v_cvt_pk_bf16_f32 v183, v242, v243
    v_rcp_f32 v248, v156
    v_mfma_f32_16x16x32_bf16 v[160:163], v[200:203], v[174:177], 0
    v_pk_mul_f32 v[84:85], v[84:85], v[248:249] op_sel_hi:[1,0]
    v_pk_mul_f32 v[86:87], v[86:87], v[248:249] op_sel_hi:[1,0]
    v_pk_mul_f32 v[88:89], v[88:89], v[248:249] op_sel_hi:[1,0]
    v_mfma_f32_16x16x32_bf16 v[116:119], a[176:179], v[174:177], 0
    v_pk_mul_f32 v[90:91], v[90:91], v[248:249] op_sel_hi:[1,0]
    v_cvt_pk_bf16_f32 v184, v84, v85
    v_cvt_pk_bf16_f32 v185, v86, v87
    v_mfma_f32_16x16x32_bf16 v[120:123], a[186:189], v[174:177], 0
    v_cvt_pk_bf16_f32 v186, v88, v89
    v_cvt_pk_bf16_f32 v187, v90, v91
    buffer_store_dwordx4 v[184:187], v7, s[40:43], s56 offen sc1
    ds_write_b128 v79, v[184:187]
    v_mfma_f32_16x16x32_bf16 v[160:163], v[200:203], v[178:181], v[160:163]
    v_pk_mul_f32 v[92:93], v[92:93], v[248:249] op_sel_hi:[1,0]
    v_pk_mul_f32 v[94:95], v[94:95], v[248:249] op_sel_hi:[1,0]
    v_pk_mul_f32 v[96:97], v[96:97], v[248:249] op_sel_hi:[1,0]
    v_mfma_f32_16x16x32_bf16 v[116:119], a[180:183], v[178:181], v[116:119]
    v_pk_mul_f32 v[98:99], v[98:99], v[248:249] op_sel_hi:[1,0]
    v_cvt_pk_bf16_f32 v188, v92, v93
    v_cvt_pk_bf16_f32 v189, v94, v95
    v_mfma_f32_16x16x32_bf16 v[120:123], a[190:193], v[178:181], v[120:123]
    v_cvt_pk_bf16_f32 v190, v96, v97
    v_cvt_pk_bf16_f32 v191, v98, v99
    buffer_store_dwordx4 v[188:191], v7, s[40:43], s57 offen sc1
    ds_write_b128 v80, v[188:191]
    v_mfma_f32_16x16x16_bf16 v[160:163], v[200:201], v[182:183], v[160:163]
    v_pk_mul_f32 v[100:101], v[100:101], v[248:249] op_sel_hi:[1,0]
    v_pk_mul_f32 v[102:103], v[102:103], v[248:249] op_sel_hi:[1,0]
    v_pk_mul_f32 v[104:105], v[104:105], v[248:249] op_sel_hi:[1,0]
    v_mfma_f32_16x16x16_bf16 v[116:119], a[184:185], v[182:183], v[116:119]
    v_pk_mul_f32 v[106:107], v[106:107], v[248:249] op_sel_hi:[1,0]
    v_cvt_pk_bf16_f32 v192, v100, v101
    v_cvt_pk_bf16_f32 v193, v102, v103
    v_mfma_f32_16x16x16_bf16 v[120:123], a[194:195], v[182:183], v[120:123]
    v_cvt_pk_bf16_f32 v194, v104, v105
    v_cvt_pk_bf16_f32 v195, v106, v107
    buffer_store_dwordx4 v[192:195], v7, s[40:43], s58 offen sc1
    ds_write_b128 v81, v[192:195]
    v_pk_mul_f32 v[108:109], v[108:109], v[248:249] op_sel_hi:[1,0]
    v_pk_mul_f32 v[110:111], v[110:111], v[248:249] op_sel_hi:[1,0]
    v_pk_mul_f32 v[112:113], v[112:113], v[248:249] op_sel_hi:[1,0]
    v_pk_mul_f32 v[114:115], v[114:115], v[248:249] op_sel_hi:[1,0]
    v_cvt_pk_bf16_f32 v196, v108, v109
    v_cvt_pk_bf16_f32 v197, v110, v111
    v_cvt_pk_bf16_f32 v198, v112, v113
    v_cvt_pk_bf16_f32 v199, v114, v115
    buffer_store_dwordx4 v[196:199], v7, s[40:43], s59 offen sc1
    ds_write_b128 v82, v[196:199]
    v_rcp_f32 v248, v160
    s_nop 0
    v_pk_mul_f32 v[116:117], v[116:117], v[248:249] op_sel_hi:[1,0]
    v_pk_mul_f32 v[118:119], v[118:119], v[248:249] op_sel_hi:[1,0]
    v_pk_mul_f32 v[120:121], v[120:121], v[248:249] op_sel_hi:[1,0]
    v_pk_mul_f32 v[122:123], v[122:123], v[248:249] op_sel_hi:[1,0]
    v_cvt_pk_bf16_f32 v200, v116, v117
    v_cvt_pk_bf16_f32 v201, v118, v119
    v_cvt_pk_bf16_f32 v202, v120, v121
    v_cvt_pk_bf16_f32 v203, v122, v123
    buffer_store_dwordx4 v[200:203], v7, s[40:43], s85 offen sc1
    ds_write_b128 v83, v[200:203]
    s_mul_i32 s83, s20, 5120
    s_add_u32 s3, s78, s79
    s_and_b32 s3, s3, 7
    s_mul_i32 s3, s3, 20480
    s_add_u32 s3, s3, s83
    v_add_u32 v19, s3, v7
    s_cmp_le_u32 s79, 1
    s_addc_u32 s3, s78, 1
    s_and_b32 s3, s3, 7
    s_mul_i32 s3, s3, 20480
    s_add_u32 s3, s3, s83
    v_add_u32 v20, s3, v7
    s_cmp_le_u32 s79, 2
    s_addc_u32 s3, s78, 2
    s_and_b32 s3, s3, 7
    s_mul_i32 s3, s3, 20480
    s_add_u32 s3, s3, s83
    v_add_u32 v21, s3, v7
    s_cmp_le_u32 s79, 3
    s_addc_u32 s3, s78, 3
    s_and_b32 s3, s3, 7
    s_mul_i32 s3, s3, 20480
    s_add_u32 s3, s3, s83
    v_add_u32 v22, s3, v7
    s_cmp_le_u32 s79, 4
    s_addc_u32 s3, s78, 4
    s_and_b32 s3, s3, 7
    s_mul_i32 s3, s3, 20480
    s_add_u32 s3, s3, s83
    v_add_u32 v23, s3, v7
    s_cmp_le_u32 s79, 5
    s_addc_u32 s3, s78, 5
    s_and_b32 s3, s3, 7
    s_mul_i32 s3, s3, 20480
    s_add_u32 s3, s3, s83
    v_add_u32 v24, s3, v7
    s_cmp_le_u32 s79, 6
    s_addc_u32 s3, s78, 6
    s_and_b32 s3, s3, 7
    s_mul_i32 s3, s3, 20480
    s_add_u32 s3, s3, s83
    v_add_u32 v25, s3, v7
    s_add_u32 s3, s77, 0
    s_and_b32 s3, s3, 3
    s_lshl_b32 s3, s3, 10
    v_add_u32 v42, s3, v78
    s_add_u32 s3, s77, 1
    s_and_b32 s3, s3, 3
    s_lshl_b32 s3, s3, 10
    v_add_u32 v43, s3, v78
    s_add_u32 s3, s77, 2
    s_and_b32 s3, s3, 3
    s_lshl_b32 s3, s3, 10
    v_add_u32 v44, s3, v78
    s_add_u32 s3, s77, 3
    s_and_b32 s3, s3, 3
    s_lshl_b32 s3, s3, 10
    v_add_u32 v45, s3, v78
    v_add_u32 v46, 4096, v78
    v_add_u32 v39, 0, v7
    v_add_u32 v40, 65536, v7
    v_add_u32 v41, 131072, v7
    s_lshl_b32 s3, s20, 6
    s_add_u32 s3, s3, 0
    v_xor_b32 v51, s3, v75
    v_add_u32 v52, 0x10000, v51
    v_add_u32 v53, 0x20000, v51
    s_lshl_b32 s3, s20, 6
    s_add_u32 s3, s3, 32
    v_xor_b32 v54, s3, v75
    v_add_u32 v55, 0x10000, v54
    v_add_u32 v56, 0x20000, v54
    s_cmp_eq_u32 s21, 0
    s_cselect_b32 s3, 0, 65536
    s_cselect_b32 s83, 65536, 0
    v_add_u32 v57, s3, v51
    v_add_u32 v59, s83, v51
    v_add_u32 v58, s3, v54
    v_add_u32 v60, s83, v54
    s_cmp_eq_u32 s20, s77
    s_cselect_b32 s24, s92, 16777216
    s_cselect_b32 s25, s93, 16777216
    s_cselect_b32 s26, s94, 16777216
    s_cselect_b32 s91, 16777216, s91
    s_cselect_b32 s29, 0xff, 0
    s_mov_b32 s28, 0x40000
    s_cselect_b32 s28, 0x20000, s28
    s_lshl_b32 s27, s77, 15
    v_readfirstlane_b32 s36, v30
    s_mov_b32 s32, 0x7060500
    s_mov_b32 s33, 0x7060501
    s_mov_b32 s34, 0x7060502
    s_mov_b32 s35, 0x7060503
    s_bfe_u32 s39, s36, 0x80018
    s_bfe_u32 s38, s36, 0x80010
    s_bfe_u32 s37, s36, 0x80008
    s_bfe_u32 s36, s36, 0x80000
    v_lshlrev_b32 v13, 11, v2
    v_lshl_add_u32 v13, v3, 4, v13
    s_cmp_eq_u32 s21, 0
    s_addc_u32 s87, s78, 0
    s_and_b32 s87, s87, 7
    s_lshl_b32 s95, s87, 18
    s_add_u32 m0, s68, 65536
    s_nop 0
    buffer_load_dwordx4 v31, s[44:47], s95 offen lds
    s_add_u32 m0, s68, 69632
    s_nop 0
    buffer_load_dwordx4 v32, s[44:47], s95 offen lds
    s_add_u32 m0, s68, 73728
    s_nop 0
    buffer_load_dwordx4 v33, s[44:47], s95 offen lds
    s_add_u32 m0, s68, 77824
    s_nop 0
    buffer_load_dwordx4 v34, s[44:47], s95 offen lds
    s_add_u32 m0, s68, 81920
    s_nop 0
    buffer_load_dwordx4 v35, s[44:47], s95 offen lds
    s_add_u32 m0, s68, 86016
    s_nop 0
    buffer_load_dwordx4 v36, s[44:47], s95 offen lds
    s_add_u32 m0, s68, 90112
    s_nop 0
    buffer_load_dwordx4 v37, s[44:47], s95 offen lds
    s_add_u32 m0, s68, 94208
    s_nop 0
    buffer_load_dwordx4 v38, s[44:47], s95 offen lds
    s_waitcnt vmcnt(8)
    buffer_store_dword v30, v28, s[52:55], 0 offen sc1
    s_cmp_le_u32 s79, 1
    s_addc_u32 s87, s78, 1
    s_and_b32 s87, s87, 7
    s_lshl_b32 s95, s87, 18
    s_add_u32 m0, s68, 32768
    s_nop 0
    buffer_load_dwordx4 v31, s[44:47], s95 offen lds
    s_add_u32 m0, s68, 36864
    s_nop 0
    buffer_load_dwordx4 v32, s[44:47], s95 offen lds
    s_add_u32 m0, s68, 40960
    s_nop 0
    buffer_load_dwordx4 v33, s[44:47], s95 offen lds
    s_add_u32 m0, s68, 45056
    s_nop 0
    buffer_load_dwordx4 v34, s[44:47], s95 offen lds
    s_add_u32 m0, s68, 49152
    s_nop 0
    buffer_load_dwordx4 v35, s[44:47], s95 offen lds
    s_add_u32 m0, s68, 53248
    s_nop 0
    buffer_load_dwordx4 v36, s[44:47], s95 offen lds
    s_waitcnt vmcnt(7) lgkmcnt(0)
    s_barrier
    s_add_u32 m0, s68, 57344
    s_nop 0
    buffer_load_dwordx4 v37, s[44:47], s95 offen lds
    ds_read_b64_tr_b16 a[0:1], v57 offset:0
    ds_read_b64_tr_b16 a[2:3], v57 offset:4096
    s_add_u32 m0, s68, 61440
    ds_read_b64_tr_b16 a[4:5], v58 offset:0
    buffer_load_dwordx4 v38, s[44:47], s95 offen lds
    ds_read_b64_tr_b16 a[6:7], v58 offset:4096
    ds_read_b64_tr_b16 a[8:9], v57 offset:8192
    ds_read_b64_tr_b16 a[10:11], v57 offset:12288
    s_cmp_le_u32 s79, 2
    s_addc_u32 s87, s78, 2
    s_and_b32 s87, s87, 7
    s_lshl_b32 s95, s87, 18
    s_add_u32 m0, s68, 131072
    s_nop 0
    buffer_load_dwordx4 v31, s[44:47], s95 offen lds
    ds_read_b64_tr_b16 a[12:13], v58 offset:8192
    ds_read_b64_tr_b16 a[14:15], v58 offset:12288
    s_add_u32 m0, s68, 135168
    ds_read_b64_tr_b16 a[16:17], v57 offset:16384
    buffer_load_dwordx4 v32, s[44:47], s95 offen lds
    ds_read_b64_tr_b16 a[18:19], v57 offset:20480
    ds_read_b64_tr_b16 a[20:21], v58 offset:16384
    s_add_u32 m0, s68, 139264
    ds_read_b64_tr_b16 a[22:23], v58 offset:20480
    buffer_load_dwordx4 v33, s[44:47], s95 offen lds
    ds_read_b64_tr_b16 a[24:25], v57 offset:24576
    ds_read_b64_tr_b16 a[26:27], v57 offset:28672
    s_add_u32 m0, s68, 143360
    ds_read_b64_tr_b16 a[28:29], v58 offset:24576
    buffer_load_dwordx4 v34, s[44:47], s95 offen lds
    s_waitcnt lgkmcnt(12)
    ds_read_b64_tr_b16 a[30:31], v58 offset:28672
    ds_read_b64_tr_b16 a[32:33], v59 offset:0
    s_add_u32 m0, s68, 147456
    ds_read_b64_tr_b16 a[34:35], v59 offset:4096
    buffer_load_dwordx4 v35, s[44:47], s95 offen lds
    s_waitcnt lgkmcnt(12)
    ds_read_b64_tr_b16 a[36:37], v60 offset:0
    ds_read_b64_tr_b16 a[38:39], v60 offset:4096
    s_add_u32 m0, s68, 151552
    ds_read_b64_tr_b16 a[40:41], v59 offset:8192
    buffer_load_dwordx4 v36, s[44:47], s95 offen lds
    s_waitcnt lgkmcnt(12)
    ds_read_b64_tr_b16 a[42:43], v59 offset:12288
    ds_read_b64_tr_b16 a[44:45], v60 offset:8192
    s_add_u32 m0, s68, 155648
    ds_read_b64_tr_b16 a[46:47], v60 offset:12288
    buffer_load_dwordx4 v37, s[44:47], s95 offen lds
    s_waitcnt lgkmcnt(12)
    ds_read_b64_tr_b16 a[48:49], v59 offset:16384
    ds_read_b64_tr_b16 a[50:51], v59 offset:20480
    s_add_u32 m0, s68, 159744
    ds_read_b64_tr_b16 a[52:53], v60 offset:16384
    buffer_load_dwordx4 v38, s[44:47], s95 offen lds
    s_waitcnt lgkmcnt(12)
    ds_read_b64_tr_b16 a[54:55], v60 offset:20480
    ds_read_b64_tr_b16 a[56:57], v59 offset:24576
    ds_read_b64_tr_b16 a[58:59], v59 offset:28672
    s_waitcnt lgkmcnt(12)
    ds_read_b64_tr_b16 a[60:61], v60 offset:24576
    ds_read_b64_tr_b16 a[62:63], v60 offset:28672
    s_waitcnt lgkmcnt(0)
    s_barrier
    ds_read_b128 v[124:127], v42 offset:0
    ds_read_b128 v[128:131], v43 offset:0
    ds_read_b128 v[132:135], v44 offset:0
    ds_read_b128 v[136:139], v45 offset:0
    ds_read_b128 v[140:143], v46 offset:0
    ds_read_b128 v[144:147], v42 offset:5120
    ds_read_b128 v[148:151], v43 offset:5120
    ds_read_b128 v[152:155], v44 offset:5120
    ds_read_b128 v[156:159], v45 offset:5120
    s_waitcnt lgkmcnt(8)
    v_mfma_f32_16x16x32_bf16 v[84:87], a[0:3], v[124:127], 0
    ds_read_b128 v[160:163], v46 offset:5120
    v_mfma_f32_16x16x32_bf16 v[104:107], a[4:7], v[124:127], 0
    s_cmp_le_u32 s79, 3
    s_addc_u32 s87, s78, 3
    s_and_b32 s87, s87, 7
    s_lshl_b32 s95, s87, 18
    s_add_u32 m0, s68, 0
    s_nop 0
    buffer_load_dwordx4 v31, s[44:47], s95 offen lds
    s_waitcnt lgkmcnt(8)
    v_mfma_f32_16x16x32_bf16 v[88:91], a[0:3], v[128:131], 0
    ds_read_b128 v[124:127], v42 offset:10240
    s_add_u32 m0, s68, 4096
    v_mfma_f32_16x16x32_bf16 v[108:111], a[4:7], v[128:131], 0
    buffer_load_dwordx4 v32, s[44:47], s95 offen lds
    s_waitcnt lgkmcnt(8)
    v_mfma_f32_16x16x32_bf16 v[92:95], a[0:3], v[132:135], 0
    ds_read_b128 v[128:131], v43 offset:10240
    v_mfma_f32_16x16x32_bf16 v[112:115], a[4:7], v[132:135], 0
    s_waitcnt lgkmcnt(8)
    v_mfma_f32_16x16x32_bf16 v[96:99], a[0:3], v[136:139], 0
    ds_read_b128 v[132:135], v44 offset:10240
    s_add_u32 m0, s68, 8192
    v_mfma_f32_16x16x32_bf16 v[116:119], a[4:7], v[136:139], 0
    buffer_load_dwordx4 v33, s[44:47], s95 offen lds
    s_waitcnt lgkmcnt(8)
    v_mfma_f32_16x16x32_bf16 v[100:103], a[0:3], v[140:143], 0
    ds_read_b128 v[136:139], v45 offset:10240
    v_mfma_f32_16x16x32_bf16 v[120:123], a[4:7], v[140:143], 0
    s_waitcnt lgkmcnt(8)
    v_mfma_f32_16x16x32_bf16 v[84:87], a[8:11], v[144:147], v[84:87]
    ds_read_b128 v[140:143], v46 offset:10240
    s_add_u32 m0, s68, 12288
    v_mfma_f32_16x16x32_bf16 v[104:107], a[12:15], v[144:147], v[104:107]
    buffer_load_dwordx4 v34, s[44:47], s95 offen lds
    s_waitcnt lgkmcnt(8)
    v_mfma_f32_16x16x32_bf16 v[88:91], a[8:11], v[148:151], v[88:91]
    ds_read_b128 v[144:147], v42 offset:15360
    s_add_u32 m0, s68, 16384
    v_mfma_f32_16x16x32_bf16 v[108:111], a[12:15], v[148:151], v[108:111]
    buffer_load_dwordx4 v35, s[44:47], s95 offen lds
    s_waitcnt lgkmcnt(8)
    v_mfma_f32_16x16x32_bf16 v[92:95], a[8:11], v[152:155], v[92:95]
    ds_read_b128 v[148:151], v43 offset:15360
    v_mfma_f32_16x16x32_bf16 v[112:115], a[12:15], v[152:155], v[112:115]
    s_waitcnt lgkmcnt(8)
    v_mfma_f32_16x16x32_bf16 v[96:99], a[8:11], v[156:159], v[96:99]
    ds_read_b128 v[152:155], v44 offset:15360
    s_add_u32 m0, s68, 20480
    v_mfma_f32_16x16x32_bf16 v[116:119], a[12:15], v[156:159], v[116:119]
    buffer_load_dwordx4 v36, s[44:47], s95 offen lds
    s_waitcnt lgkmcnt(8)
    v_mfma_f32_16x16x32_bf16 v[100:103], a[8:11], v[160:163], v[100:103]
    ds_read_b128 v[156:159], v45 offset:15360
    v_mfma_f32_16x16x32_bf16 v[120:123], a[12:15], v[160:163], v[120:123]
    s_waitcnt lgkmcnt(8)
    v_mfma_f32_16x16x32_bf16 v[84:87], a[16:19], v[124:127], v[84:87]
    ds_read_b128 v[160:163], v46 offset:15360
    s_add_u32 m0, s68, 24576
    v_mfma_f32_16x16x32_bf16 v[104:107], a[20:23], v[124:127], v[104:107]
    buffer_load_dwordx4 v37, s[44:47], s95 offen lds
    s_waitcnt lgkmcnt(8)
    v_mfma_f32_16x16x32_bf16 v[88:91], a[16:19], v[128:131], v[88:91]
    s_add_u32 m0, s68, 28672
    v_mfma_f32_16x16x32_bf16 v[108:111], a[20:23], v[128:131], v[108:111]
    buffer_load_dwordx4 v38, s[44:47], s95 offen lds
    s_waitcnt lgkmcnt(7)
    v_mfma_f32_16x16x32_bf16 v[92:95], a[16:19], v[132:135], v[92:95]
    v_mfma_f32_16x16x32_bf16 v[112:115], a[20:23], v[132:135], v[112:115]
    s_waitcnt lgkmcnt(6)
    v_mfma_f32_16x16x32_bf16 v[96:99], a[16:19], v[136:139], v[96:99]
    v_mfma_f32_16x16x32_bf16 v[116:119], a[20:23], v[136:139], v[116:119]
    s_cmp_le_u32 s79, 4
    s_addc_u32 s87, s78, 4
    s_and_b32 s87, s87, 7
    s_lshl_b32 s95, s87, 18
    s_add_u32 m0, s68, 65536
    s_nop 0
    buffer_load_dwordx4 v31, s[44:47], s95 offen lds
    s_waitcnt lgkmcnt(5)
    v_mfma_f32_16x16x32_bf16 v[100:103], a[16:19], v[140:143], v[100:103]
    v_mfma_f32_16x16x32_bf16 v[120:123], a[20:23], v[140:143], v[120:123]
    s_waitcnt lgkmcnt(4)
    v_mfma_f32_16x16x32_bf16 v[84:87], a[24:27], v[144:147], v[84:87]
    s_add_u32 m0, s68, 69632
    v_mfma_f32_16x16x32_bf16 v[104:107], a[28:31], v[144:147], v[104:107]
    buffer_load_dwordx4 v32, s[44:47], s95 offen lds
    s_waitcnt lgkmcnt(3)
    v_mfma_f32_16x16x32_bf16 v[88:91], a[24:27], v[148:151], v[88:91]
    s_add_u32 m0, s68, 73728
    v_mfma_f32_16x16x32_bf16 v[108:111], a[28:31], v[148:151], v[108:111]
    buffer_load_dwordx4 v33, s[44:47], s95 offen lds
    s_waitcnt lgkmcnt(2)
    v_mfma_f32_16x16x32_bf16 v[92:95], a[24:27], v[152:155], v[92:95]
    v_mfma_f32_16x16x32_bf16 v[112:115], a[28:31], v[152:155], v[112:115]
    s_waitcnt lgkmcnt(1)
    v_mfma_f32_16x16x32_bf16 v[96:99], a[24:27], v[156:159], v[96:99]
    s_add_u32 m0, s68, 77824
    v_mfma_f32_16x16x32_bf16 v[116:119], a[28:31], v[156:159], v[116:119]
    buffer_load_dwordx4 v34, s[44:47], s95 offen lds
    s_waitcnt lgkmcnt(0)
    v_mfma_f32_16x16x32_bf16 v[100:103], a[24:27], v[160:163], v[100:103]
    v_mfma_f32_16x16x32_bf16 v[120:123], a[28:31], v[160:163], v[120:123]
    s_waitcnt vmcnt(12)
    s_barrier
    s_add_u32 m0, s68, 81920
    s_nop 0
    buffer_load_dwordx4 v35, s[44:47], s95 offen lds
    ds_read_b64_tr_b16 a[64:65], v51 offset:32768
    ds_read_b64_tr_b16 a[66:67], v51 offset:36864
    ds_read_b64_tr_b16 a[68:69], v54 offset:32768
    s_add_u32 m0, s68, 86016
    ds_read_b64_tr_b16 a[70:71], v54 offset:36864
    buffer_load_dwordx4 v36, s[44:47], s95 offen lds
    ds_read_b64_tr_b16 a[72:73], v51 offset:40960
    ds_read_b64_tr_b16 a[74:75], v51 offset:45056
    ds_read_b64_tr_b16 a[76:77], v54 offset:40960
    s_add_u32 m0, s68, 90112
    ds_read_b64_tr_b16 a[78:79], v54 offset:45056
    buffer_load_dwordx4 v37, s[44:47], s95 offen lds
    ds_read_b64_tr_b16 a[80:81], v51 offset:49152
    ds_read_b64_tr_b16 a[82:83], v51 offset:53248
    ds_read_b64_tr_b16 a[84:85], v54 offset:49152
    s_add_u32 m0, s68, 94208
    ds_read_b64_tr_b16 a[86:87], v54 offset:53248
    buffer_load_dwordx4 v38, s[44:47], s95 offen lds
    ds_read_b64_tr_b16 a[88:89], v51 offset:57344
    ds_read_b64_tr_b16 a[90:91], v51 offset:61440
    ds_read_b64_tr_b16 a[92:93], v54 offset:57344
    s_waitcnt lgkmcnt(12)
    ds_read_b64_tr_b16 a[94:95], v54 offset:61440
    buffer_load_dword v77, v76, s[52:55], 0 offen sc1
    ds_read_b64_tr_b16 a[96:97], v53 offset:0
    ds_read_b64_tr_b16 a[98:99], v53 offset:4096
    s_waitcnt lgkmcnt(12)
    ds_read_b64_tr_b16 a[100:101], v56 offset:0
    ds_read_b64_tr_b16 a[102:103], v56 offset:4096
    s_cmp_le_u32 s79, 5
    s_addc_u32 s87, s78, 5
    s_and_b32 s87, s87, 7
    s_lshl_b32 s95, s87, 18
    s_add_u32 m0, s68, 98304
    s_nop 0
    buffer_load_dwordx4 v31, s[44:47], s95 offen lds
    ds_read_b64_tr_b16 a[104:105], v53 offset:8192
    s_waitcnt lgkmcnt(12)
    ds_read_b64_tr_b16 a[106:107], v53 offset:12288
    ds_read_b64_tr_b16 a[108:109], v56 offset:8192
    s_add_u32 m0, s68, 102400
    ds_read_b64_tr_b16 a[110:111], v56 offset:12288
    buffer_load_dwordx4 v32, s[44:47], s95 offen lds
    s_waitcnt lgkmcnt(12)
    ds_read_b64_tr_b16 a[112:113], v53 offset:16384
    ds_read_b64_tr_b16 a[114:115], v53 offset:20480
    ds_read_b64_tr_b16 a[116:117], v56 offset:16384
    s_waitcnt lgkmcnt(12)
    s_add_u32 m0, s68, 106496
    ds_read_b64_tr_b16 a[118:119], v56 offset:20480
    buffer_load_dwordx4 v33, s[44:47], s95 offen lds
    ds_read_b64_tr_b16 a[120:121], v53 offset:24576
    ds_read_b64_tr_b16 a[122:123], v53 offset:28672
    s_waitcnt lgkmcnt(12)
    ds_read_b64_tr_b16 a[124:125], v56 offset:24576
    s_add_u32 m0, s68, 110592
    ds_read_b64_tr_b16 a[126:127], v56 offset:28672
    buffer_load_dwordx4 v34, s[44:47], s95 offen lds
    s_add_u32 m0, s68, 114688
    s_nop 0
    buffer_load_dwordx4 v35, s[44:47], s95 offen lds
    s_add_u32 m0, s68, 118784
    s_nop 0
    buffer_load_dwordx4 v36, s[44:47], s95 offen lds
    s_add_u32 m0, s68, 122880
    s_nop 0
    buffer_load_dwordx4 v37, s[44:47], s95 offen lds
    s_add_u32 m0, s68, 126976
    s_nop 0
    buffer_load_dwordx4 v38, s[44:47], s95 offen lds
    s_waitcnt vmcnt(8) lgkmcnt(0)
    s_barrier
L_p1:
    v_cmp_ne_u32 vcc, v30, v77
    s_nop 1
    s_cbranch_vccnz L_p1_slow
L_p1_done:
    s_mov_b32 s70, 4096
    s_add_u32 m0, s68, 32768
    s_nop 0
    buffer_load_dwordx4 v19, s[48:51], s70 offen sc1 lds
    ds_read_b64_tr_b16 a[128:129], v51 offset:0
    ds_read_b64_tr_b16 a[130:131], v51 offset:4096
    s_add_u32 m0, s68, 36864
    ds_read_b64_tr_b16 a[132:133], v54 offset:0
    buffer_load_dwordx4 v20, s[48:51], s70 offen sc1 lds
    ds_read_b64_tr_b16 a[134:135], v54 offset:4096
    ds_read_b64_tr_b16 a[136:137], v51 offset:8192
    s_add_u32 m0, s68, 40960
    ds_read_b64_tr_b16 a[138:139], v51 offset:12288
    buffer_load_dwordx4 v21, s[48:51], s70 offen sc1 lds
    ds_read_b64_tr_b16 a[140:141], v54 offset:8192
    ds_read_b64_tr_b16 a[142:143], v54 offset:12288
    s_add_u32 m0, s68, 45056
    ds_read_b64_tr_b16 a[144:145], v51 offset:16384
    buffer_load_dwordx4 v22, s[48:51], s70 offen sc1 lds
    ds_read_b64_tr_b16 a[146:147], v51 offset:20480
    ds_read_b64_tr_b16 a[148:149], v54 offset:16384
    s_add_u32 m0, s68, 49152
    ds_read_b64_tr_b16 a[150:151], v54 offset:20480
    buffer_load_dwordx4 v23, s[48:51], s70 offen sc1 lds
    ds_read_b64_tr_b16 a[152:153], v51 offset:24576
    ds_read_b64_tr_b16 a[154:155], v51 offset:28672
    s_add_u32 m0, s68, 53248
    ds_read_b64_tr_b16 a[156:157], v54 offset:24576
    buffer_load_dwordx4 v24, s[48:51], s70 offen sc1 lds
    s_waitcnt lgkmcnt(12)
    ds_read_b64_tr_b16 a[158:159], v54 offset:28672
    ds_read_b64_tr_b16 a[160:161], v52 offset:0
    s_add_u32 m0, s68, 57344
    ds_read_b64_tr_b16 a[162:163], v52 offset:4096
    buffer_load_dwordx4 v25, s[48:51], s70 offen sc1 lds
    s_waitcnt lgkmcnt(12)
    ds_read_b64_tr_b16 a[164:165], v55 offset:0
    ds_read_b64_tr_b16 a[166:167], v55 offset:4096
    ds_read_b64_tr_b16 a[168:169], v52 offset:8192
    s_waitcnt lgkmcnt(12)
    ds_read_b64_tr_b16 a[170:171], v52 offset:12288
    ds_read_b64_tr_b16 a[172:173], v55 offset:8192
    ds_read_b64_tr_b16 a[174:175], v55 offset:12288
    s_waitcnt lgkmcnt(12)
    ds_read_b64_tr_b16 a[176:177], v52 offset:16384
    ds_read_b64_tr_b16 a[178:179], v52 offset:20480
    ds_read_b64_tr_b16 a[180:181], v55 offset:16384
    s_waitcnt lgkmcnt(12)
    ds_read_b64_tr_b16 a[182:183], v55 offset:20480
    ds_read_b64_tr_b16 a[184:185], v52 offset:24576
    ds_read_b64_tr_b16 a[186:187], v52 offset:28672
    s_waitcnt lgkmcnt(12)
    ds_read_b64_tr_b16 a[188:189], v55 offset:24576
    ds_read_b64_tr_b16 a[190:191], v55 offset:28672
    s_cmp_le_u32 s79, 6
    s_addc_u32 s87, s78, 6
    s_and_b32 s87, s87, 7
    s_lshl_b32 s95, s87, 18
    s_add_u32 m0, s68, 131072
    s_nop 0
    buffer_load_dwordx4 v31, s[44:47], s95 offen lds
    s_add_u32 m0, s68, 135168
    s_nop 0
    buffer_load_dwordx4 v32, s[44:47], s95 offen lds
    s_add_u32 m0, s68, 139264
    s_nop 0
    buffer_load_dwordx4 v33, s[44:47], s95 offen lds
    s_add_u32 m0, s68, 143360
    s_nop 0
    buffer_load_dwordx4 v34, s[44:47], s95 offen lds
    s_add_u32 m0, s68, 147456
    s_nop 0
    buffer_load_dwordx4 v35, s[44:47], s95 offen lds
    s_add_u32 m0, s68, 151552
    s_nop 0
    buffer_load_dwordx4 v36, s[44:47], s95 offen lds
    s_waitcnt vmcnt(13) lgkmcnt(0)
    s_barrier
    s_add_u32 m0, s68, 155648
    s_nop 0
    buffer_load_dwordx4 v37, s[44:47], s95 offen lds
    ds_read_b64_tr_b16 a[192:193], v52 offset:32768
    ds_read_b64_tr_b16 a[194:195], v52 offset:36864
    ds_read_b64_tr_b16 a[196:197], v55 offset:32768
    s_add_u32 m0, s68, 159744
    ds_read_b64_tr_b16 a[198:199], v55 offset:36864
    buffer_load_dwordx4 v38, s[44:47], s95 offen lds
    ds_read_b64_tr_b16 a[200:201], v52 offset:40960
    ds_read_b64_tr_b16 a[202:203], v52 offset:45056
    ds_read_b64_tr_b16 a[204:205], v55 offset:40960
    ds_read_b64_tr_b16 a[206:207], v55 offset:45056
    ds_read_b64_tr_b16 a[208:209], v52 offset:49152
    ds_read_b64_tr_b16 a[210:211], v52 offset:53248
    ds_read_b64_tr_b16 a[212:213], v55 offset:49152
    ds_read_b64_tr_b16 a[214:215], v55 offset:53248
    ds_read_b64_tr_b16 a[216:217], v52 offset:57344
    ds_read_b64_tr_b16 a[218:219], v52 offset:61440
    ds_read_b64_tr_b16 a[220:221], v55 offset:57344
    s_waitcnt lgkmcnt(12)
    ds_read_b64_tr_b16 a[222:223], v55 offset:61440
    v_mov_b32 v15, 16777216
    s_add_u32 s3, s93, 2032
    v_writelane_b32 v15, s3, 1
    s_add_u32 s3, s92, 2032
    v_writelane_b32 v15, s3, 0
    s_and_b32 s3, s2, 31
    s_or_b32 s3, s3, s20
    s_cmp_eq_u32 s3, 0
    s_cselect_b32 s40, 0, 0x100000
    v_and_b32 v61, 31, v1
    v_add_u32 v61, s2, v61
    v_lshlrev_b32 v61, 7, v61
    v_add_u32 v61, s40, v61
    v_lshl_add_u32 v29, v1, 20, v29
    v_add_u32 v29, s40, v29
    s_waitcnt vmcnt(8) lgkmcnt(0)
    s_barrier
    ds_read_b128 v[124:127], v39 offset:32768
    ds_read_b128 v[128:131], v39 offset:33792
    ds_read_b128 v[132:135], v39 offset:34816
    ds_read_b128 v[136:139], v39 offset:35840
    ds_read_b128 v[140:143], v39 offset:36864
    ds_read_b128 v[144:147], v39 offset:37888
    ds_read_b128 v[148:151], v39 offset:38912
    ds_read_b128 v[152:155], v39 offset:39936
    ds_read_b128 v[156:159], v39 offset:40960
    s_waitcnt lgkmcnt(8)
    v_mfma_f32_16x16x32_bf16 v[100:103], a[32:35], v[124:127], v[100:103]
    ds_read_b128 v[160:163], v39 offset:41984
    v_mfma_f32_16x16x32_bf16 v[120:123], a[36:39], v[124:127], v[120:123]
    s_add_u32 s87, s77, 1
    s_and_b32 s87, s87, 3
    s_lshl_b32 s70, s87, 10
    s_add_u32 m0, s68, 0
    s_nop 0
    buffer_load_dwordx4 v19, s[48:51], s70 offen sc1 lds
    s_waitcnt lgkmcnt(8)
    v_mfma_f32_16x16x32_bf16 v[100:103], a[40:43], v[128:131], v[100:103]
    ds_read_b128 v[124:127], v39 offset:43008
    s_add_u32 m0, s68, 4096
    v_mfma_f32_16x16x32_bf16 v[120:123], a[44:47], v[128:131], v[120:123]
    buffer_load_dwordx4 v20, s[48:51], s70 offen sc1 lds
    s_waitcnt lgkmcnt(8)
    v_mfma_f32_16x16x32_bf16 v[100:103], a[48:51], v[132:135], v[100:103]
    ds_read_b128 v[128:131], v39 offset:44032
    s_add_u32 m0, s68, 8192
    v_mfma_f32_16x16x32_bf16 v[120:123], a[52:55], v[132:135], v[120:123]
    buffer_load_dwordx4 v21, s[48:51], s70 offen sc1 lds
    s_waitcnt lgkmcnt(8)
    v_mfma_f32_16x16x32_bf16 v[100:103], a[56:59], v[136:139], v[100:103]
    ds_read_b128 v[132:135], v39 offset:45056
    s_add_u32 m0, s68, 12288
    v_mfma_f32_16x16x32_bf16 v[120:123], a[60:63], v[136:139], v[120:123]
    buffer_load_dwordx4 v22, s[48:51], s70 offen sc1 lds
    s_waitcnt lgkmcnt(8)
    v_mfma_f32_16x16x32_bf16 v[100:103], a[64:67], v[140:143], v[100:103]
    ds_read_b128 v[136:139], v39 offset:46080
    v_mfma_f32_16x16x32_bf16 v[120:123], a[68:71], v[140:143], v[120:123]
    s_waitcnt lgkmcnt(8)
    v_mfma_f32_16x16x32_bf16 v[100:103], a[72:75], v[144:147], v[100:103]
    ds_read_b128 v[140:143], v39 offset:47104
    s_add_u32 m0, s68, 16384
    v_mfma_f32_16x16x32_bf16 v[120:123], a[76:79], v[144:147], v[120:123]
    buffer_load_dwordx4 v23, s[48:51], s70 offen sc1 lds
    s_waitcnt lgkmcnt(8)
    v_mfma_f32_16x16x32_bf16 v[100:103], a[80:83], v[148:151], v[100:103]
    ds_read_b128 v[144:147], v39 offset:48128
    s_add_u32 m0, s68, 20480
    v_mfma_f32_16x16x32_bf16 v[120:123], a[84:87], v[148:151], v[120:123]
    buffer_load_dwordx4 v24, s[48:51], s70 offen sc1 lds
    s_waitcnt lgkmcnt(8)
    v_mfma_f32_16x16x32_bf16 v[100:103], a[88:91], v[152:155], v[100:103]
    ds_read_b128 v[148:151], v39 offset:49152
    s_add_u32 m0, s68, 24576
    v_mfma_f32_16x16x32_bf16 v[120:123], a[92:95], v[152:155], v[120:123]
    buffer_load_dwordx4 v25, s[48:51], s70 offen sc1 lds
    s_waitcnt lgkmcnt(8)
    v_mfma_f32_16x16x32_bf16 v[100:103], a[96:99], v[156:159], v[100:103]
    ds_read_b128 v[152:155], v39 offset:50176
    v_mfma_f32_16x16x32_bf16 v[120:123], a[100:103], v[156:159], v[120:123]
    s_waitcnt lgkmcnt(8)
    v_mfma_f32_16x16x32_bf16 v[100:103], a[104:107], v[160:163], v[100:103]
    ds_read_b128 v[156:159], v39 offset:51200
    v_mfma_f32_16x16x32_bf16 v[120:123], a[108:111], v[160:163], v[120:123]
    s_waitcnt lgkmcnt(8)
    v_mfma_f32_16x16x32_bf16 v[100:103], a[112:115], v[124:127], v[100:103]
    ds_read_b128 v[160:163], v39 offset:52224
    v_mfma_f32_16x16x32_bf16 v[120:123], a[116:119], v[124:127], v[120:123]
    s_waitcnt vmcnt(7)
    s_barrier
    s_waitcnt lgkmcnt(8)
    v_mfma_f32_16x16x32_bf16 v[100:103], a[120:123], v[128:131], v[100:103]
    ds_read_b128 v[124:127], v39 offset:53248
    v_mfma_f32_16x16x32_bf16 v[120:123], a[124:127], v[128:131], v[120:123]
    ds_read_b64_tr_b16 a[224:225], v53 offset:0
    ds_read_b64_tr_b16 a[226:227], v53 offset:4096
    ds_read_b64_tr_b16 a[228:229], v56 offset:0
    s_waitcnt lgkmcnt(11)
    v_mfma_f32_16x16x32_bf16 v[100:103], a[128:131], v[132:135], v[100:103]
    ds_read_b128 v[128:131], v39 offset:54272
    v_mfma_f32_16x16x32_bf16 v[120:123], a[132:135], v[132:135], v[120:123]
    ds_read_b64_tr_b16 a[230:231], v56 offset:4096
    ds_read_b64_tr_b16 a[232:233], v53 offset:8192
    s_add_u32 s87, s77, 2
    s_and_b32 s87, s87, 3
    s_lshl_b32 s70, s87, 10
    s_add_u32 m0, s68, 65536
    s_nop 0
    buffer_load_dwordx4 v19, s[48:51], s70 offen sc1 lds
    s_waitcnt lgkmcnt(13)
    v_mfma_f32_16x16x32_bf16 v[100:103], a[136:139], v[136:139], v[100:103]
    ds_read_b128 v[132:135], v39 offset:55296
    v_mfma_f32_16x16x32_bf16 v[120:123], a[140:143], v[136:139], v[120:123]
    ds_read_b64_tr_b16 a[234:235], v53 offset:12288
    s_waitcnt lgkmcnt(12)
    ds_read_b64_tr_b16 a[236:237], v56 offset:8192
    v_mfma_f32_16x16x32_bf16 v[100:103], a[144:147], v[140:143], v[100:103]
    ds_read_b128 v[136:139], v39 offset:56320
    v_mfma_f32_16x16x32_bf16 v[120:123], a[148:151], v[140:143], v[120:123]
    ds_read_b64_tr_b16 a[238:239], v56 offset:12288
    s_waitcnt lgkmcnt(12)
    ds_read_b64_tr_b16 a[240:241], v53 offset:16384
    s_add_u32 m0, s68, 69632
    ds_read_b64_tr_b16 a[242:243], v53 offset:20480
    buffer_load_dwordx4 v20, s[48:51], s70 offen sc1 lds
    v_mfma_f32_16x16x32_bf16 v[100:103], a[152:155], v[144:147], v[100:103]
    ds_read_b128 v[140:143], v39 offset:57344
    v_mfma_f32_16x16x32_bf16 v[120:123], a[156:159], v[144:147], v[120:123]
    s_waitcnt lgkmcnt(12)
    ds_read_b64_tr_b16 a[244:245], v56 offset:16384
    ds_read_b64_tr_b16 a[246:247], v56 offset:20480
    v_mfma_f32_16x16x32_bf16 v[100:103], a[160:163], v[148:151], v[100:103]
    ds_read_b128 v[144:147], v39 offset:58368
    v_mfma_f32_16x16x32_bf16 v[120:123], a[164:167], v[148:151], v[120:123]
    s_waitcnt lgkmcnt(12)
    ds_read_b64_tr_b16 a[248:249], v53 offset:24576
    s_add_u32 m0, s68, 73728
    ds_read_b64_tr_b16 a[250:251], v53 offset:28672
    buffer_load_dwordx4 v21, s[48:51], s70 offen sc1 lds
    v_mfma_f32_16x16x32_bf16 v[100:103], a[168:171], v[152:155], v[100:103]
    ds_read_b128 v[148:151], v39 offset:59392
    v_mfma_f32_16x16x32_bf16 v[120:123], a[172:175], v[152:155], v[120:123]
    s_waitcnt lgkmcnt(12)
    ds_read_b64_tr_b16 a[252:253], v56 offset:24576
    ds_read_b64_tr_b16 a[254:255], v56 offset:28672
    v_mfma_f32_16x16x32_bf16 v[100:103], a[176:179], v[156:159], v[100:103]
    ds_read_b128 v[152:155], v39 offset:60416
    s_add_u32 m0, s68, 77824
    v_mfma_f32_16x16x32_bf16 v[120:123], a[180:183], v[156:159], v[120:123]
    buffer_load_dwordx4 v22, s[48:51], s70 offen sc1 lds
    v_mfma_f32_16x16x32_bf16 v[100:103], a[184:187], v[160:163], v[100:103]
    s_waitcnt vmcnt(4) lgkmcnt(1)
    s_barrier
    ds_read_b128 v[156:159], v39 offset:0
    v_mfma_f32_16x16x32_bf16 v[120:123], a[188:191], v[160:163], v[120:123]
    v_mfma_f32_16x16x32_bf16 v[100:103], a[192:195], v[124:127], v[100:103]
    ds_read_b128 v[160:163], v39 offset:1024
    s_add_u32 m0, s68, 81920
    v_mfma_f32_16x16x32_bf16 v[120:123], a[196:199], v[124:127], v[120:123]
    buffer_load_dwordx4 v23, s[48:51], s70 offen sc1 lds
    v_mfma_f32_16x16x32_bf16 v[100:103], a[200:203], v[128:131], v[100:103]
    ds_read_b128 v[124:127], v39 offset:2048
    v_mfma_f32_16x16x32_bf16 v[120:123], a[204:207], v[128:131], v[120:123]
    v_mfma_f32_16x16x32_bf16 v[100:103], a[208:211], v[132:135], v[100:103]
    ds_read_b128 v[128:131], v39 offset:3072
    s_add_u32 m0, s68, 86016
    v_mfma_f32_16x16x32_bf16 v[120:123], a[212:215], v[132:135], v[120:123]
    buffer_load_dwordx4 v24, s[48:51], s70 offen sc1 lds
    v_mfma_f32_16x16x32_bf16 v[100:103], a[216:219], v[136:139], v[100:103]
    ds_read_b128 v[132:135], v39 offset:4096
    v_mfma_f32_16x16x32_bf16 v[120:123], a[220:223], v[136:139], v[120:123]
    v_mfma_f32_16x16x32_bf16 v[100:103], a[224:227], v[140:143], v[100:103]
    ds_read_b128 v[136:139], v39 offset:5120
    s_add_u32 m0, s68, 90112
    v_mfma_f32_16x16x32_bf16 v[120:123], a[228:231], v[140:143], v[120:123]
    buffer_load_dwordx4 v25, s[48:51], s70 offen sc1 lds
    v_mfma_f32_16x16x32_bf16 v[100:103], a[232:235], v[144:147], v[100:103]
    ds_read_b128 v[140:143], v39 offset:6144
    v_mfma_f32_16x16x32_bf16 v[120:123], a[236:239], v[144:147], v[120:123]
    v_mfma_f32_16x16x32_bf16 v[100:103], a[240:243], v[148:151], v[100:103]
    ds_read_b128 v[144:147], v39 offset:7168
    v_mfma_f32_16x16x32_bf16 v[120:123], a[244:247], v[148:151], v[120:123]
    s_waitcnt lgkmcnt(8)
    v_mfma_f32_16x16x32_bf16 v[100:103], a[248:251], v[152:155], v[100:103]
    ds_read_b128 v[148:151], v39 offset:8192
    v_mfma_f32_16x16x32_bf16 v[120:123], a[252:255], v[152:155], v[120:123]
    s_waitcnt lgkmcnt(8)
    v_mfma_f32_16x16x32_bf16 v[88:91], a[32:35], v[156:159], v[88:91]
    ds_read_b128 v[152:155], v39 offset:9216
    v_mfma_f32_16x16x32_bf16 v[108:111], a[36:39], v[156:159], v[108:111]
    s_waitcnt lgkmcnt(8)
    v_mfma_f32_16x16x32_bf16 v[88:91], a[40:43], v[160:163], v[88:91]
    ds_read_b128 v[156:159], v39 offset:10240
    v_mfma_f32_16x16x32_bf16 v[108:111], a[44:47], v[160:163], v[108:111]
    s_waitcnt lgkmcnt(8)
    v_mfma_f32_16x16x32_bf16 v[88:91], a[48:51], v[124:127], v[88:91]
    ds_read_b128 v[160:163], v39 offset:11264
    v_mfma_f32_16x16x32_bf16 v[108:111], a[52:55], v[124:127], v[108:111]
    v_perm_b32 v176, v100, v30, s32
    v_perm_b32 v177, v101, v30, s33
    s_waitcnt lgkmcnt(8)
    v_mfma_f32_16x16x32_bf16 v[88:91], a[56:59], v[128:131], v[88:91]
    ds_read_b128 v[124:127], v39 offset:12288
    v_mfma_f32_16x16x32_bf16 v[108:111], a[60:63], v[128:131], v[108:111]
    v_perm_b32 v178, v102, v30, s34
    v_perm_b32 v179, v103, v30, s35
    s_waitcnt lgkmcnt(8)
    v_mfma_f32_16x16x32_bf16 v[88:91], a[64:67], v[132:135], v[88:91]
    ds_read_b128 v[128:131], v39 offset:13312
    v_mfma_f32_16x16x32_bf16 v[108:111], a[68:71], v[132:135], v[108:111]
    buffer_store_dwordx4 v[176:179], v7, s[60:63], s91 offen offset:2048 sc1
    v_perm_b32 v180, v120, v30, s32
    v_perm_b32 v181, v121, v30, s33
    s_waitcnt lgkmcnt(8)
    v_mfma_f32_16x16x32_bf16 v[88:91], a[72:75], v[136:139], v[88:91]
    ds_read_b128 v[132:135], v39 offset:14336
    v_mfma_f32_16x16x32_bf16 v[108:111], a[76:79], v[136:139], v[108:111]
    v_perm_b32 v182, v122, v30, s34
    v_perm_b32 v183, v123, v30, s35
    s_waitcnt lgkmcnt(8)
    v_mfma_f32_16x16x32_bf16 v[88:91], a[80:83], v[140:143], v[88:91]
    ds_read_b128 v[136:139], v39 offset:15360
    v_mfma_f32_16x16x32_bf16 v[108:111], a[84:87], v[140:143], v[108:111]
    buffer_store_dwordx4 v[180:183], v7, s[60:63], s91 offen offset:3072 sc1
    s_waitcnt lgkmcnt(8)
    v_mfma_f32_16x16x32_bf16 v[88:91], a[88:91], v[144:147], v[88:91]
    ds_read_b128 v[140:143], v39 offset:16384
    v_mfma_f32_16x16x32_bf16 v[108:111], a[92:95], v[144:147], v[108:111]
    s_waitcnt lgkmcnt(8)
    v_mfma_f32_16x16x32_bf16 v[88:91], a[96:99], v[148:151], v[88:91]
    ds_read_b128 v[144:147], v39 offset:17408
    v_mfma_f32_16x16x32_bf16 v[108:111], a[100:103], v[148:151], v[108:111]
    s_add_u32 s87, s77, 3
    s_and_b32 s87, s87, 3
    s_lshl_b32 s70, s87, 10
    s_add_u32 m0, s68, 98304
    s_nop 0
    buffer_load_dwordx4 v19, s[48:51], s70 offen sc1 lds
    s_waitcnt lgkmcnt(8)
    v_mfma_f32_16x16x32_bf16 v[88:91], a[104:107], v[152:155], v[88:91]
    ds_read_b128 v[148:151], v39 offset:18432
    s_add_u32 m0, s68, 102400
    v_mfma_f32_16x16x32_bf16 v[108:111], a[108:111], v[152:155], v[108:111]
    buffer_load_dwordx4 v20, s[48:51], s70 offen sc1 lds
    s_waitcnt lgkmcnt(8)
    v_mfma_f32_16x16x32_bf16 v[88:91], a[112:115], v[156:159], v[88:91]
    ds_read_b128 v[152:155], v39 offset:19456
    s_add_u32 m0, s68, 106496
    v_mfma_f32_16x16x32_bf16 v[108:111], a[116:119], v[156:159], v[108:111]
    buffer_load_dwordx4 v21, s[48:51], s70 offen sc1 lds
    s_waitcnt lgkmcnt(8)
    v_mfma_f32_16x16x32_bf16 v[88:91], a[120:123], v[160:163], v[88:91]
    ds_read_b128 v[156:159], v39 offset:20480
    v_mfma_f32_16x16x32_bf16 v[108:111], a[124:127], v[160:163], v[108:111]
    s_waitcnt lgkmcnt(8)
    v_mfma_f32_16x16x32_bf16 v[88:91], a[128:131], v[124:127], v[88:91]
    ds_read_b128 v[160:163], v39 offset:21504
    s_add_u32 m0, s68, 110592
    v_mfma_f32_16x16x32_bf16 v[108:111], a[132:135], v[124:127], v[108:111]
    buffer_load_dwordx4 v22, s[48:51], s70 offen sc1 lds
    s_waitcnt lgkmcnt(8)
    v_mfma_f32_16x16x32_bf16 v[88:91], a[136:139], v[128:131], v[88:91]
    ds_read_b128 v[124:127], v39 offset:22528
    s_add_u32 m0, s68, 114688
    v_mfma_f32_16x16x32_bf16 v[108:111], a[140:143], v[128:131], v[108:111]
    buffer_load_dwordx4 v23, s[48:51], s70 offen sc1 lds
    s_waitcnt lgkmcnt(8)
    v_mfma_f32_16x16x32_bf16 v[88:91], a[144:147], v[132:135], v[88:91]
    ds_read_b128 v[128:131], v39 offset:23552
    v_mfma_f32_16x16x32_bf16 v[108:111], a[148:151], v[132:135], v[108:111]
    s_waitcnt lgkmcnt(8)
    v_mfma_f32_16x16x32_bf16 v[88:91], a[152:155], v[136:139], v[88:91]
    ds_read_b128 v[132:135], v39 offset:24576
    s_add_u32 m0, s68, 118784
    v_mfma_f32_16x16x32_bf16 v[108:111], a[156:159], v[136:139], v[108:111]
    buffer_load_dwordx4 v24, s[48:51], s70 offen sc1 lds
    s_waitcnt lgkmcnt(8)
    v_mfma_f32_16x16x32_bf16 v[88:91], a[160:163], v[140:143], v[88:91]
    ds_read_b128 v[136:139], v39 offset:25600
    s_add_u32 m0, s68, 122880
    v_mfma_f32_16x16x32_bf16 v[108:111], a[164:167], v[140:143], v[108:111]
    buffer_load_dwordx4 v25, s[48:51], s70 offen sc1 lds
    s_waitcnt lgkmcnt(8)
    v_mfma_f32_16x16x32_bf16 v[88:91], a[168:171], v[144:147], v[88:91]
    ds_read_b128 v[140:143], v39 offset:26624
    v_mfma_f32_16x16x32_bf16 v[108:111], a[172:175], v[144:147], v[108:111]
    s_waitcnt lgkmcnt(8)
    v_mfma_f32_16x16x32_bf16 v[88:91], a[176:179], v[148:151], v[88:91]
    ds_read_b128 v[144:147], v39 offset:27648
    v_mfma_f32_16x16x32_bf16 v[108:111], a[180:183], v[148:151], v[108:111]
    s_waitcnt lgkmcnt(8)
    v_mfma_f32_16x16x32_bf16 v[88:91], a[184:187], v[152:155], v[88:91]
    s_waitcnt vmcnt(9)
    s_barrier
    ds_read_b128 v[148:151], v40 offset:0
    v_mfma_f32_16x16x32_bf16 v[108:111], a[188:191], v[152:155], v[108:111]
    s_waitcnt lgkmcnt(8)
    v_mfma_f32_16x16x32_bf16 v[88:91], a[192:195], v[156:159], v[88:91]
    ds_read_b128 v[152:155], v40 offset:1024
    v_mfma_f32_16x16x32_bf16 v[108:111], a[196:199], v[156:159], v[108:111]
    s_waitcnt lgkmcnt(8)
    v_mfma_f32_16x16x32_bf16 v[88:91], a[200:203], v[160:163], v[88:91]
    ds_read_b128 v[156:159], v40 offset:2048
    v_mfma_f32_16x16x32_bf16 v[108:111], a[204:207], v[160:163], v[108:111]
    s_waitcnt lgkmcnt(8)
    v_mfma_f32_16x16x32_bf16 v[88:91], a[208:211], v[124:127], v[88:91]
    ds_read_b128 v[160:163], v40 offset:3072
    v_mfma_f32_16x16x32_bf16 v[108:111], a[212:215], v[124:127], v[108:111]
    s_waitcnt lgkmcnt(8)
    v_mfma_f32_16x16x32_bf16 v[88:91], a[216:219], v[128:131], v[88:91]
    ds_read_b128 v[124:127], v40 offset:4096
    v_mfma_f32_16x16x32_bf16 v[108:111], a[220:223], v[128:131], v[108:111]
    s_waitcnt lgkmcnt(8)
    v_mfma_f32_16x16x32_bf16 v[88:91], a[224:227], v[132:135], v[88:91]
    ds_read_b128 v[128:131], v40 offset:5120
    v_mfma_f32_16x16x32_bf16 v[108:111], a[228:231], v[132:135], v[108:111]
    s_waitcnt lgkmcnt(8)
    v_mfma_f32_16x16x32_bf16 v[88:91], a[232:235], v[136:139], v[88:91]
    ds_read_b128 v[132:135], v40 offset:6144
    v_mfma_f32_16x16x32_bf16 v[108:111], a[236:239], v[136:139], v[108:111]
    s_waitcnt lgkmcnt(8)
    v_mfma_f32_16x16x32_bf16 v[88:91], a[240:243], v[140:143], v[88:91]
    ds_read_b128 v[136:139], v40 offset:7168
    v_mfma_f32_16x16x32_bf16 v[108:111], a[244:247], v[140:143], v[108:111]
    s_waitcnt lgkmcnt(8)
    v_mfma_f32_16x16x32_bf16 v[88:91], a[248:251], v[144:147], v[88:91]
    ds_read_b128 v[140:143], v40 offset:8192
    v_mfma_f32_16x16x32_bf16 v[108:111], a[252:255], v[144:147], v[108:111]
    s_waitcnt lgkmcnt(8)
    v_mfma_f32_16x16x32_bf16 v[92:95], a[32:35], v[148:151], v[92:95]
    ds_read_b128 v[144:147], v40 offset:9216
    v_mfma_f32_16x16x32_bf16 v[112:115], a[36:39], v[148:151], v[112:115]
    buffer_load_dwordx4 v[172:175], v61, s[52:55], 0 offen sc1
    s_waitcnt lgkmcnt(8)
    v_mfma_f32_16x16x32_bf16 v[92:95], a[40:43], v[152:155], v[92:95]
    ds_read_b128 v[148:151], v40 offset:10240
    v_mfma_f32_16x16x32_bf16 v[112:115], a[44:47], v[152:155], v[112:115]
    s_waitcnt lgkmcnt(8)
    v_mfma_f32_16x16x32_bf16 v[92:95], a[48:51], v[156:159], v[92:95]
    ds_read_b128 v[152:155], v40 offset:11264
    v_mfma_f32_16x16x32_bf16 v[112:115], a[52:55], v[156:159], v[112:115]
    v_perm_b32 v88, v88, v30, s32
    v_perm_b32 v89, v89, v30, s33
    s_waitcnt lgkmcnt(8)
    v_mfma_f32_16x16x32_bf16 v[92:95], a[56:59], v[160:163], v[92:95]
    ds_read_b128 v[156:159], v40 offset:12288
    v_mfma_f32_16x16x32_bf16 v[112:115], a[60:63], v[160:163], v[112:115]
    v_perm_b32 v90, v90, v30, s34
    v_perm_b32 v91, v91, v30, s35
    s_waitcnt lgkmcnt(8)
    v_mfma_f32_16x16x32_bf16 v[92:95], a[64:67], v[124:127], v[92:95]
    ds_read_b128 v[160:163], v40 offset:13312
    v_mfma_f32_16x16x32_bf16 v[112:115], a[68:71], v[124:127], v[112:115]
    buffer_store_dwordx4 v[88:91], v7, s[60:63], s88 offen offset:0 sc1
    v_perm_b32 v108, v108, v30, s32
    v_perm_b32 v109, v109, v30, s33
    s_waitcnt lgkmcnt(8)
    v_mfma_f32_16x16x32_bf16 v[92:95], a[72:75], v[128:131], v[92:95]
    ds_read_b128 v[124:127], v40 offset:14336
    v_mfma_f32_16x16x32_bf16 v[112:115], a[76:79], v[128:131], v[112:115]
    v_perm_b32 v110, v110, v30, s34
    v_perm_b32 v111, v111, v30, s35
    s_waitcnt lgkmcnt(8)
    v_mfma_f32_16x16x32_bf16 v[92:95], a[80:83], v[132:135], v[92:95]
    ds_read_b128 v[128:131], v40 offset:15360
    v_mfma_f32_16x16x32_bf16 v[112:115], a[84:87], v[132:135], v[112:115]
    buffer_store_dwordx4 v[108:111], v7, s[60:63], s88 offen offset:1024 sc1
    s_waitcnt lgkmcnt(8)
    v_mfma_f32_16x16x32_bf16 v[92:95], a[88:91], v[136:139], v[92:95]
    ds_read_b128 v[132:135], v40 offset:16384
    v_mfma_f32_16x16x32_bf16 v[112:115], a[92:95], v[136:139], v[112:115]
    s_add_u32 s87, s77, 0
    s_and_b32 s87, s87, 3
    s_lshl_b32 s70, s87, 10
    s_add_u32 m0, s68, 131072
    s_nop 0
    buffer_load_dwordx4 v19, s[48:51], s70 offen sc1 lds
    s_waitcnt lgkmcnt(8)
    v_mfma_f32_16x16x32_bf16 v[92:95], a[96:99], v[140:143], v[92:95]
    ds_read_b128 v[136:139], v40 offset:17408
    s_add_u32 m0, s68, 135168
    v_mfma_f32_16x16x32_bf16 v[112:115], a[100:103], v[140:143], v[112:115]
    buffer_load_dwordx4 v20, s[48:51], s70 offen sc1 lds
    s_waitcnt lgkmcnt(8)
    v_mfma_f32_16x16x32_bf16 v[92:95], a[104:107], v[144:147], v[92:95]
    ds_read_b128 v[140:143], v40 offset:18432
    s_add_u32 m0, s68, 139264
    v_mfma_f32_16x16x32_bf16 v[112:115], a[108:111], v[144:147], v[112:115]
    buffer_load_dwordx4 v21, s[48:51], s70 offen sc1 lds
    s_waitcnt lgkmcnt(8)
    v_mfma_f32_16x16x32_bf16 v[92:95], a[112:115], v[148:151], v[92:95]
    ds_read_b128 v[144:147], v40 offset:19456
    s_add_u32 m0, s68, 143360
    v_mfma_f32_16x16x32_bf16 v[112:115], a[116:119], v[148:151], v[112:115]
    buffer_load_dwordx4 v22, s[48:51], s70 offen sc1 lds
    s_waitcnt lgkmcnt(8)
    v_mfma_f32_16x16x32_bf16 v[92:95], a[120:123], v[152:155], v[92:95]
    ds_read_b128 v[148:151], v40 offset:20480
    s_add_u32 m0, s68, 147456
    v_mfma_f32_16x16x32_bf16 v[112:115], a[124:127], v[152:155], v[112:115]
    buffer_load_dwordx4 v23, s[48:51], s70 offen sc1 lds
    s_waitcnt lgkmcnt(8)
    v_mfma_f32_16x16x32_bf16 v[92:95], a[128:131], v[156:159], v[92:95]
    ds_read_b128 v[152:155], v40 offset:21504
    s_add_u32 m0, s68, 151552
    v_mfma_f32_16x16x32_bf16 v[112:115], a[132:135], v[156:159], v[112:115]
    buffer_load_dwordx4 v24, s[48:51], s70 offen sc1 lds
    s_waitcnt lgkmcnt(8)
    v_mfma_f32_16x16x32_bf16 v[92:95], a[136:139], v[160:163], v[92:95]
    ds_read_b128 v[156:159], v40 offset:22528
    s_add_u32 m0, s68, 155648
    v_mfma_f32_16x16x32_bf16 v[112:115], a[140:143], v[160:163], v[112:115]
    buffer_load_dwordx4 v25, s[48:51], s70 offen sc1 lds
    s_waitcnt lgkmcnt(8)
    v_mfma_f32_16x16x32_bf16 v[92:95], a[144:147], v[124:127], v[92:95]
    ds_read_b128 v[160:163], v40 offset:23552
    v_mfma_f32_16x16x32_bf16 v[112:115], a[148:151], v[124:127], v[112:115]
    s_waitcnt lgkmcnt(8)
    v_mfma_f32_16x16x32_bf16 v[92:95], a[152:155], v[128:131], v[92:95]
    ds_read_b128 v[124:127], v40 offset:24576
    v_mfma_f32_16x16x32_bf16 v[112:115], a[156:159], v[128:131], v[112:115]
    s_waitcnt lgkmcnt(8)
    v_mfma_f32_16x16x32_bf16 v[92:95], a[160:163], v[132:135], v[92:95]
    ds_read_b128 v[128:131], v40 offset:25600
    v_mfma_f32_16x16x32_bf16 v[112:115], a[164:167], v[132:135], v[112:115]
    s_waitcnt lgkmcnt(8)
    v_mfma_f32_16x16x32_bf16 v[92:95], a[168:171], v[136:139], v[92:95]
    ds_read_b128 v[132:135], v40 offset:26624
    v_mfma_f32_16x16x32_bf16 v[112:115], a[172:175], v[136:139], v[112:115]
    s_waitcnt lgkmcnt(8)
    v_mfma_f32_16x16x32_bf16 v[92:95], a[176:179], v[140:143], v[92:95]
    ds_read_b128 v[136:139], v40 offset:27648
    v_mfma_f32_16x16x32_bf16 v[112:115], a[180:183], v[140:143], v[112:115]
    s_waitcnt lgkmcnt(8)
    v_mfma_f32_16x16x32_bf16 v[92:95], a[184:187], v[144:147], v[92:95]
    s_waitcnt vmcnt(10)
    s_barrier
    ds_read_b128 v[140:143], v40 offset:32768
    v_mfma_f32_16x16x32_bf16 v[112:115], a[188:191], v[144:147], v[112:115]
    s_waitcnt lgkmcnt(8)
    v_mfma_f32_16x16x32_bf16 v[92:95], a[192:195], v[148:151], v[92:95]
    ds_read_b128 v[144:147], v40 offset:33792
    v_mfma_f32_16x16x32_bf16 v[112:115], a[196:199], v[148:151], v[112:115]
    s_waitcnt lgkmcnt(8)
    v_mfma_f32_16x16x32_bf16 v[92:95], a[200:203], v[152:155], v[92:95]
    ds_read_b128 v[148:151], v40 offset:34816
    v_mfma_f32_16x16x32_bf16 v[112:115], a[204:207], v[152:155], v[112:115]
    s_waitcnt lgkmcnt(8)
    v_mfma_f32_16x16x32_bf16 v[92:95], a[208:211], v[156:159], v[92:95]
    ds_read_b128 v[152:155], v40 offset:35840
    v_mfma_f32_16x16x32_bf16 v[112:115], a[212:215], v[156:159], v[112:115]
    s_waitcnt lgkmcnt(8)
    v_mfma_f32_16x16x32_bf16 v[92:95], a[216:219], v[160:163], v[92:95]
    ds_read_b128 v[156:159], v40 offset:36864
    v_mfma_f32_16x16x32_bf16 v[112:115], a[220:223], v[160:163], v[112:115]
    s_waitcnt lgkmcnt(8)
    v_mfma_f32_16x16x32_bf16 v[92:95], a[224:227], v[124:127], v[92:95]
    ds_read_b128 v[160:163], v40 offset:37888
    v_mfma_f32_16x16x32_bf16 v[112:115], a[228:231], v[124:127], v[112:115]
    s_waitcnt lgkmcnt(8)
    v_mfma_f32_16x16x32_bf16 v[92:95], a[232:235], v[128:131], v[92:95]
    ds_read_b128 v[124:127], v40 offset:38912
    v_mfma_f32_16x16x32_bf16 v[112:115], a[236:239], v[128:131], v[112:115]
    s_waitcnt lgkmcnt(8)
    v_mfma_f32_16x16x32_bf16 v[92:95], a[240:243], v[132:135], v[92:95]
    ds_read_b128 v[128:131], v40 offset:39936
    v_mfma_f32_16x16x32_bf16 v[112:115], a[244:247], v[132:135], v[112:115]
    s_waitcnt vmcnt(9)
    v_xor_b32 v172, v30, v172
    v_xor_b32 v173, v30, v173
    v_xor_b32 v174, v30, v174
    v_xor_b32 v175, v30, v175
    s_waitcnt lgkmcnt(8)
    v_mfma_f32_16x16x32_bf16 v[92:95], a[248:251], v[136:139], v[92:95]
    ds_read_b128 v[132:135], v40 offset:40960
    v_mfma_f32_16x16x32_bf16 v[112:115], a[252:255], v[136:139], v[112:115]
    v_or_b32 v172, v172, v173
    v_or3_b32 v172, v172, v174, v175
    v_cmp_ne_u32 vcc, 0, v172
    s_waitcnt lgkmcnt(8)
    v_mfma_f32_16x16x32_bf16 v[96:99], a[32:35], v[140:143], v[96:99]
    ds_read_b128 v[136:139], v40 offset:41984
    v_mfma_f32_16x16x32_bf16 v[116:119], a[36:39], v[140:143], v[116:119]
    s_cmp_eq_u64 vcc, 0
    s_cselect_b32 s31, 0, 0x100000
    s_waitcnt lgkmcnt(8)
    v_mfma_f32_16x16x32_bf16 v[96:99], a[40:43], v[144:147], v[96:99]
    ds_read_b128 v[140:143], v40 offset:43008
    v_mfma_f32_16x16x32_bf16 v[116:119], a[44:47], v[144:147], v[116:119]
    buffer_store_dword v26, v29, s[52:55], s31 offen sc1
    s_waitcnt lgkmcnt(8)
    v_mfma_f32_16x16x32_bf16 v[96:99], a[48:51], v[148:151], v[96:99]
    ds_read_b128 v[144:147], v40 offset:44032
    v_mfma_f32_16x16x32_bf16 v[116:119], a[52:55], v[148:151], v[116:119]
    v_perm_b32 v92, v92, v30, s32
    v_perm_b32 v93, v93, v30, s33
    s_waitcnt lgkmcnt(8)
    v_mfma_f32_16x16x32_bf16 v[96:99], a[56:59], v[152:155], v[96:99]
    ds_read_b128 v[148:151], v40 offset:45056
    v_mfma_f32_16x16x32_bf16 v[116:119], a[60:63], v[152:155], v[116:119]
    v_perm_b32 v94, v94, v30, s34
    v_perm_b32 v95, v95, v30, s35
    s_waitcnt lgkmcnt(8)
    v_mfma_f32_16x16x32_bf16 v[96:99], a[64:67], v[156:159], v[96:99]
    ds_read_b128 v[152:155], v40 offset:46080
    v_mfma_f32_16x16x32_bf16 v[116:119], a[68:71], v[156:159], v[116:119]
    buffer_store_dwordx4 v[92:95], v7, s[60:63], s89 offen offset:0 sc1
    v_perm_b32 v112, v112, v30, s32
    v_perm_b32 v113, v113, v30, s33
    s_waitcnt lgkmcnt(8)
    v_mfma_f32_16x16x32_bf16 v[96:99], a[72:75], v[160:163], v[96:99]
    ds_read_b128 v[156:159], v40 offset:47104
    v_mfma_f32_16x16x32_bf16 v[116:119], a[76:79], v[160:163], v[116:119]
    v_perm_b32 v114, v114, v30, s34
    v_perm_b32 v115, v115, v30, s35
    s_waitcnt lgkmcnt(8)
    v_mfma_f32_16x16x32_bf16 v[96:99], a[80:83], v[124:127], v[96:99]
    ds_read_b128 v[160:163], v40 offset:48128
    v_mfma_f32_16x16x32_bf16 v[116:119], a[84:87], v[124:127], v[116:119]
    buffer_store_dwordx4 v[112:115], v7, s[60:63], s89 offen offset:1024 sc1
    s_waitcnt lgkmcnt(8)
    v_mfma_f32_16x16x32_bf16 v[96:99], a[88:91], v[128:131], v[96:99]
    ds_read_b128 v[124:127], v40 offset:49152
    v_mfma_f32_16x16x32_bf16 v[116:119], a[92:95], v[128:131], v[116:119]
    s_waitcnt lgkmcnt(8)
    v_mfma_f32_16x16x32_bf16 v[96:99], a[96:99], v[132:135], v[96:99]
    ds_read_b128 v[128:131], v40 offset:50176
    v_mfma_f32_16x16x32_bf16 v[116:119], a[100:103], v[132:135], v[116:119]
    s_waitcnt lgkmcnt(8)
    v_mfma_f32_16x16x32_bf16 v[96:99], a[104:107], v[136:139], v[96:99]
    ds_read_b128 v[132:135], v40 offset:51200
    v_mfma_f32_16x16x32_bf16 v[116:119], a[108:111], v[136:139], v[116:119]
    s_waitcnt lgkmcnt(8)
    v_mfma_f32_16x16x32_bf16 v[96:99], a[112:115], v[140:143], v[96:99]
    ds_read_b128 v[136:139], v40 offset:52224
    v_mfma_f32_16x16x32_bf16 v[116:119], a[116:119], v[140:143], v[116:119]
    s_waitcnt lgkmcnt(8)
    v_mfma_f32_16x16x32_bf16 v[96:99], a[120:123], v[144:147], v[96:99]
    ds_read_b128 v[140:143], v40 offset:53248
    v_mfma_f32_16x16x32_bf16 v[116:119], a[124:127], v[144:147], v[116:119]
    s_waitcnt lgkmcnt(8)
    v_mfma_f32_16x16x32_bf16 v[96:99], a[128:131], v[148:151], v[96:99]
    ds_read_b128 v[144:147], v40 offset:54272
    v_mfma_f32_16x16x32_bf16 v[116:119], a[132:135], v[148:151], v[116:119]
    s_waitcnt lgkmcnt(8)
    v_mfma_f32_16x16x32_bf16 v[96:99], a[136:139], v[152:155], v[96:99]
    ds_read_b128 v[148:151], v40 offset:55296
    v_mfma_f32_16x16x32_bf16 v[116:119], a[140:143], v[152:155], v[116:119]
    s_waitcnt lgkmcnt(8)
    v_mfma_f32_16x16x32_bf16 v[96:99], a[144:147], v[156:159], v[96:99]
    ds_read_b128 v[152:155], v40 offset:56320
    v_mfma_f32_16x16x32_bf16 v[116:119], a[148:151], v[156:159], v[116:119]
    s_waitcnt lgkmcnt(8)
    v_mfma_f32_16x16x32_bf16 v[96:99], a[152:155], v[160:163], v[96:99]
    ds_read_b128 v[156:159], v40 offset:57344
    v_mfma_f32_16x16x32_bf16 v[116:119], a[156:159], v[160:163], v[116:119]
    s_waitcnt lgkmcnt(8)
    v_mfma_f32_16x16x32_bf16 v[96:99], a[160:163], v[124:127], v[96:99]
    ds_read_b128 v[160:163], v40 offset:58368
    v_mfma_f32_16x16x32_bf16 v[116:119], a[164:167], v[124:127], v[116:119]
    s_waitcnt lgkmcnt(8)
    v_mfma_f32_16x16x32_bf16 v[96:99], a[168:171], v[128:131], v[96:99]
    ds_read_b128 v[124:127], v40 offset:59392
    v_mfma_f32_16x16x32_bf16 v[116:119], a[172:175], v[128:131], v[116:119]
    s_waitcnt lgkmcnt(8)
    v_mfma_f32_16x16x32_bf16 v[96:99], a[176:179], v[132:135], v[96:99]
    ds_read_b128 v[128:131], v40 offset:60416
    v_mfma_f32_16x16x32_bf16 v[116:119], a[180:183], v[132:135], v[116:119]
    s_waitcnt lgkmcnt(8)
    v_mfma_f32_16x16x32_bf16 v[96:99], a[184:187], v[136:139], v[96:99]
    s_waitcnt vmcnt(3)
    s_barrier
    ds_read_b128 v[132:135], v41 offset:0
    v_mfma_f32_16x16x32_bf16 v[116:119], a[188:191], v[136:139], v[116:119]
    s_waitcnt lgkmcnt(8)
    v_mfma_f32_16x16x32_bf16 v[96:99], a[192:195], v[140:143], v[96:99]
    ds_read_b128 v[136:139], v41 offset:1024
    v_mfma_f32_16x16x32_bf16 v[116:119], a[196:199], v[140:143], v[116:119]
    buffer_load_dwordx4 v[228:231], v7, s[60:63], s24 offen offset:2048 sc1
    s_waitcnt lgkmcnt(8)
    v_mfma_f32_16x16x32_bf16 v[96:99], a[200:203], v[144:147], v[96:99]
    ds_read_b128 v[140:143], v41 offset:2048
    v_mfma_f32_16x16x32_bf16 v[116:119], a[204:207], v[144:147], v[116:119]
    buffer_load_dwordx4 v[232:235], v7, s[60:63], s24 offen offset:3072 sc1
    s_waitcnt lgkmcnt(8)
    v_mfma_f32_16x16x32_bf16 v[96:99], a[208:211], v[148:151], v[96:99]
    ds_read_b128 v[144:147], v41 offset:3072
    v_mfma_f32_16x16x32_bf16 v[116:119], a[212:215], v[148:151], v[116:119]
    buffer_load_dwordx4 v[236:239], v7, s[60:63], s25 offen offset:2048 sc1
    s_waitcnt lgkmcnt(8)
    v_mfma_f32_16x16x32_bf16 v[96:99], a[216:219], v[152:155], v[96:99]
    ds_read_b128 v[148:151], v41 offset:4096
    v_mfma_f32_16x16x32_bf16 v[116:119], a[220:223], v[152:155], v[116:119]
    buffer_load_dwordx4 v[240:243], v7, s[60:63], s25 offen offset:3072 sc1
    s_waitcnt lgkmcnt(8)
    v_mfma_f32_16x16x32_bf16 v[96:99], a[224:227], v[156:159], v[96:99]
    ds_read_b128 v[152:155], v41 offset:5120
    v_mfma_f32_16x16x32_bf16 v[116:119], a[228:231], v[156:159], v[116:119]
    buffer_load_dwordx4 v[164:167], v7, s[60:63], s26 offen offset:2048 sc1
    s_waitcnt lgkmcnt(8)
    v_mfma_f32_16x16x32_bf16 v[96:99], a[232:235], v[160:163], v[96:99]
    ds_read_b128 v[156:159], v41 offset:6144
    v_mfma_f32_16x16x32_bf16 v[116:119], a[236:239], v[160:163], v[116:119]
    buffer_load_dwordx4 v[168:171], v7, s[60:63], s26 offen offset:3072 sc1
    s_waitcnt lgkmcnt(8)
    v_mfma_f32_16x16x32_bf16 v[96:99], a[240:243], v[124:127], v[96:99]
    ds_read_b128 v[160:163], v41 offset:7168
    v_mfma_f32_16x16x32_bf16 v[116:119], a[244:247], v[124:127], v[116:119]
    buffer_load_dwordx4 v[220:223], v7, s[60:63], s94 offen offset:0 sc1
    s_waitcnt lgkmcnt(8)
    v_mfma_f32_16x16x32_bf16 v[96:99], a[248:251], v[128:131], v[96:99]
    ds_read_b128 v[124:127], v41 offset:8192
    v_mfma_f32_16x16x32_bf16 v[116:119], a[252:255], v[128:131], v[116:119]
    buffer_load_dwordx4 v[224:227], v7, s[60:63], s94 offen offset:1024 sc1
    s_waitcnt lgkmcnt(8)
    v_mfma_f32_16x16x32_bf16 v[84:87], a[32:35], v[132:135], v[84:87]
    ds_read_b128 v[128:131], v41 offset:9216
    v_mfma_f32_16x16x32_bf16 v[104:107], a[36:39], v[132:135], v[104:107]
    s_waitcnt lgkmcnt(8)
    v_mfma_f32_16x16x32_bf16 v[84:87], a[40:43], v[136:139], v[84:87]
    ds_read_b128 v[132:135], v41 offset:10240
    v_mfma_f32_16x16x32_bf16 v[104:107], a[44:47], v[136:139], v[104:107]
    s_waitcnt lgkmcnt(8)
    v_mfma_f32_16x16x32_bf16 v[84:87], a[48:51], v[140:143], v[84:87]
    ds_read_b128 v[136:139], v41 offset:11264
    v_mfma_f32_16x16x32_bf16 v[104:107], a[52:55], v[140:143], v[104:107]
    v_perm_b32 v96, v96, v30, s32
    v_perm_b32 v97, v97, v30, s33
    s_waitcnt lgkmcnt(8)
    v_mfma_f32_16x16x32_bf16 v[84:87], a[56:59], v[144:147], v[84:87]
    ds_read_b128 v[140:143], v41 offset:12288
    v_mfma_f32_16x16x32_bf16 v[104:107], a[60:63], v[144:147], v[104:107]
    v_perm_b32 v98, v98, v30, s34
    v_perm_b32 v99, v99, v30, s35
    s_waitcnt lgkmcnt(8)
    v_mfma_f32_16x16x32_bf16 v[84:87], a[64:67], v[148:151], v[84:87]
    ds_read_b128 v[144:147], v41 offset:13312
    v_mfma_f32_16x16x32_bf16 v[104:107], a[68:71], v[148:151], v[104:107]
    buffer_store_dwordx4 v[96:99], v7, s[60:63], s90 offen offset:0 sc1
    v_perm_b32 v116, v116, v30, s32
    v_perm_b32 v117, v117, v30, s33
    s_waitcnt lgkmcnt(8)
    v_mfma_f32_16x16x32_bf16 v[84:87], a[72:75], v[152:155], v[84:87]
    ds_read_b128 v[148:151], v41 offset:14336
    v_mfma_f32_16x16x32_bf16 v[104:107], a[76:79], v[152:155], v[104:107]
    v_perm_b32 v118, v118, v30, s34
    v_perm_b32 v119, v119, v30, s35
    s_waitcnt lgkmcnt(8)
    v_mfma_f32_16x16x32_bf16 v[84:87], a[80:83], v[156:159], v[84:87]
    ds_read_b128 v[152:155], v41 offset:15360
    v_mfma_f32_16x16x32_bf16 v[104:107], a[84:87], v[156:159], v[104:107]
    buffer_store_dwordx4 v[116:119], v7, s[60:63], s90 offen offset:1024 sc1
    s_waitcnt lgkmcnt(8)
    v_mfma_f32_16x16x32_bf16 v[84:87], a[88:91], v[160:163], v[84:87]
    ds_read_b128 v[156:159], v41 offset:16384
    v_mfma_f32_16x16x32_bf16 v[104:107], a[92:95], v[160:163], v[104:107]
    s_waitcnt lgkmcnt(8)
    v_mfma_f32_16x16x32_bf16 v[84:87], a[96:99], v[124:127], v[84:87]
    ds_read_b128 v[160:163], v41 offset:17408
    v_mfma_f32_16x16x32_bf16 v[104:107], a[100:103], v[124:127], v[104:107]
    s_waitcnt lgkmcnt(8)
    v_mfma_f32_16x16x32_bf16 v[84:87], a[104:107], v[128:131], v[84:87]
    ds_read_b128 v[124:127], v41 offset:18432
    v_mfma_f32_16x16x32_bf16 v[104:107], a[108:111], v[128:131], v[104:107]
    s_waitcnt lgkmcnt(8)
    v_mfma_f32_16x16x32_bf16 v[84:87], a[112:115], v[132:135], v[84:87]
    ds_read_b128 v[128:131], v41 offset:19456
    v_mfma_f32_16x16x32_bf16 v[104:107], a[116:119], v[132:135], v[104:107]
    s_waitcnt lgkmcnt(8)
    v_mfma_f32_16x16x32_bf16 v[84:87], a[120:123], v[136:139], v[84:87]
    ds_read_b128 v[132:135], v41 offset:20480
    v_mfma_f32_16x16x32_bf16 v[104:107], a[124:127], v[136:139], v[104:107]
    s_waitcnt lgkmcnt(8)
    v_mfma_f32_16x16x32_bf16 v[84:87], a[128:131], v[140:143], v[84:87]
    ds_read_b128 v[136:139], v41 offset:21504
    v_mfma_f32_16x16x32_bf16 v[104:107], a[132:135], v[140:143], v[104:107]
    s_waitcnt lgkmcnt(8)
    v_mfma_f32_16x16x32_bf16 v[84:87], a[136:139], v[144:147], v[84:87]
    ds_read_b128 v[140:143], v41 offset:22528
    v_mfma_f32_16x16x32_bf16 v[104:107], a[140:143], v[144:147], v[104:107]
    s_waitcnt lgkmcnt(8)
    v_mfma_f32_16x16x32_bf16 v[84:87], a[144:147], v[148:151], v[84:87]
    ds_read_b128 v[144:147], v41 offset:23552
    v_mfma_f32_16x16x32_bf16 v[104:107], a[148:151], v[148:151], v[104:107]
    s_waitcnt lgkmcnt(8)
    v_mfma_f32_16x16x32_bf16 v[84:87], a[152:155], v[152:155], v[84:87]
    ds_read_b128 v[148:151], v41 offset:24576
    v_mfma_f32_16x16x32_bf16 v[104:107], a[156:159], v[152:155], v[104:107]
    s_waitcnt lgkmcnt(8)
    v_mfma_f32_16x16x32_bf16 v[84:87], a[160:163], v[156:159], v[84:87]
    ds_read_b128 v[152:155], v41 offset:25600
    v_mfma_f32_16x16x32_bf16 v[104:107], a[164:167], v[156:159], v[104:107]
    s_waitcnt lgkmcnt(8)
    v_mfma_f32_16x16x32_bf16 v[84:87], a[168:171], v[160:163], v[84:87]
    ds_read_b128 v[156:159], v41 offset:26624
    v_mfma_f32_16x16x32_bf16 v[104:107], a[172:175], v[160:163], v[104:107]
    s_waitcnt lgkmcnt(8)
    v_mfma_f32_16x16x32_bf16 v[84:87], a[176:179], v[124:127], v[84:87]
    ds_read_b128 v[160:163], v41 offset:27648
    v_mfma_f32_16x16x32_bf16 v[104:107], a[180:183], v[124:127], v[104:107]
    s_waitcnt lgkmcnt(8)
    v_mfma_f32_16x16x32_bf16 v[84:87], a[184:187], v[128:131], v[84:87]
    v_mfma_f32_16x16x32_bf16 v[104:107], a[188:191], v[128:131], v[104:107]
    s_waitcnt lgkmcnt(7)
    v_mfma_f32_16x16x32_bf16 v[84:87], a[192:195], v[132:135], v[84:87]
    v_mfma_f32_16x16x32_bf16 v[104:107], a[196:199], v[132:135], v[104:107]
    s_waitcnt lgkmcnt(6)
    v_mfma_f32_16x16x32_bf16 v[84:87], a[200:203], v[136:139], v[84:87]
    v_mfma_f32_16x16x32_bf16 v[104:107], a[204:207], v[136:139], v[104:107]
    s_waitcnt lgkmcnt(5)
    v_mfma_f32_16x16x32_bf16 v[84:87], a[208:211], v[140:143], v[84:87]
    v_mfma_f32_16x16x32_bf16 v[104:107], a[212:215], v[140:143], v[104:107]
    s_waitcnt lgkmcnt(4)
    v_mfma_f32_16x16x32_bf16 v[84:87], a[216:219], v[144:147], v[84:87]
    v_mfma_f32_16x16x32_bf16 v[104:107], a[220:223], v[144:147], v[104:107]
    s_waitcnt lgkmcnt(3)
    v_mfma_f32_16x16x32_bf16 v[84:87], a[224:227], v[148:151], v[84:87]
    v_mfma_f32_16x16x32_bf16 v[104:107], a[228:231], v[148:151], v[104:107]
    v_mov_b32 v14, 0
    buffer_atomic_add v14, v15, s[60:63], 0 offen sc0 sc1
    s_waitcnt lgkmcnt(2)
    v_mfma_f32_16x16x32_bf16 v[84:87], a[232:235], v[152:155], v[84:87]
    v_mfma_f32_16x16x32_bf16 v[104:107], a[236:239], v[152:155], v[104:107]
    s_waitcnt lgkmcnt(1)
    v_mfma_f32_16x16x32_bf16 v[84:87], a[240:243], v[156:159], v[84:87]
    v_mfma_f32_16x16x32_bf16 v[104:107], a[244:247], v[156:159], v[104:107]
    s_waitcnt lgkmcnt(0)
    v_mfma_f32_16x16x32_bf16 v[84:87], a[248:251], v[160:163], v[84:87]
    v_mfma_f32_16x16x32_bf16 v[104:107], a[252:255], v[160:163], v[104:107]
    v_mov_b32 v16, 0
    buffer_atomic_add v16, v15, s[60:63], 0 offen sc0 sc1
    s_or_b32 s83, s29, 15
    s_and_b32 s83, s83, 3
    s_waitcnt vmcnt(1)
    v_and_b32 v14, 0xff, v14
    v_cmp_eq_u32 vcc, s36, v14
    s_nop 3
    s_and_b32 s3, vcc_lo, s83
    s_cmp_eq_u32 s3, s83
    s_cbranch_scc0 L_a_slow
L_a_go:
    buffer_load_dwordx4 v[212:215], v7, s[60:63], s93 offen offset:0 sc1
    buffer_load_dwordx4 v[216:219], v7, s[60:63], s93 offen offset:1024 sc1
    buffer_load_dwordx4 v[204:207], v7, s[60:63], s92 offen offset:0 sc1
    buffer_load_dwordx4 v[208:211], v7, s[60:63], s92 offen offset:1024 sc1
L_c0:
    v_mov_b32 v244, 0
    v_mov_b32 v245, 0
    v_xor_b32 v228, s36, v228
    v_xor_b32 v229, s37, v229
    v_xor_b32 v230, s38, v230
    v_xor_b32 v231, s39, v231
    v_or3_b32 v245, v245, v228, v229
    v_or3_b32 v245, v245, v230, v231
    v_xor_b32 v232, s36, v232
    v_xor_b32 v233, s37, v233
    v_xor_b32 v234, s38, v234
    v_xor_b32 v235, s39, v235
    v_or3_b32 v245, v245, v232, v233
    v_or3_b32 v245, v245, v234, v235
    v_xor_b32 v236, s36, v236
    v_xor_b32 v237, s37, v237
    v_xor_b32 v238, s38, v238
    v_xor_b32 v239, s39, v239
    v_or3_b32 v245, v245, v236, v237
    v_or3_b32 v245, v245, v238, v239
    v_xor_b32 v240, s36, v240
    v_xor_b32 v241, s37, v241
    v_xor_b32 v242, s38, v242
    v_xor_b32 v243, s39, v243
    v_or3_b32 v245, v245, v240, v241
    v_or3_b32 v245, v245, v242, v243
    v_xor_b32 v164, s36, v164
    v_xor_b32 v165, s37, v165
    v_xor_b32 v166, s38, v166
    v_xor_b32 v167, s39, v167
    v_or3_b32 v245, v245, v164, v165
    v_or3_b32 v245, v245, v166, v167
    v_xor_b32 v168, s36, v168
    v_xor_b32 v169, s37, v169
    v_xor_b32 v170, s38, v170
    v_xor_b32 v171, s39, v171
    v_or3_b32 v245, v245, v168, v169
    v_or3_b32 v245, v245, v170, v171
    v_xor_b32 v220, s36, v220
    v_xor_b32 v221, s37, v221
    v_xor_b32 v222, s38, v222
    v_xor_b32 v223, s39, v223
    v_or3_b32 v244, v244, v220, v221
    v_or3_b32 v244, v244, v222, v223
    v_xor_b32 v224, s36, v224
    v_xor_b32 v225, s37, v225
    v_xor_b32 v226, s38, v226
    v_xor_b32 v227, s39, v227
    v_or3_b32 v244, v244, v224, v225
    v_or3_b32 v244, v244, v226, v227
    v_and_b32 v244, 0xff, v244
    v_and_or_b32 v244, v245, s29, v244
    v_cmp_ne_u32 vcc, 0, v244
    s_nop 1
    s_cbranch_vccnz L_c0_slow
L_c0_done:
    v_pk_add_f32 v[100:101], v[100:101], v[164:165]
    v_pk_add_f32 v[102:103], v[102:103], v[166:167]
    v_pk_add_f32 v[120:121], v[120:121], v[168:169]
    v_pk_add_f32 v[122:123], v[122:123], v[170:171]
    v_pk_add_f32 v[100:101], v[100:101], v[236:237]
    v_pk_add_f32 v[102:103], v[102:103], v[238:239]
    v_pk_add_f32 v[120:121], v[120:121], v[240:241]
    v_pk_add_f32 v[122:123], v[122:123], v[242:243]
    v_pk_add_f32 v[100:101], v[100:101], v[228:229]
    v_pk_add_f32 v[102:103], v[102:103], v[230:231]
    v_pk_add_f32 v[120:121], v[120:121], v[232:233]
    v_pk_add_f32 v[122:123], v[122:123], v[234:235]
    v_pk_add_f32 v[84:85], v[84:85], v[220:221]
    v_pk_add_f32 v[86:87], v[86:87], v[222:223]
    v_pk_add_f32 v[104:105], v[104:105], v[224:225]
    v_pk_add_f32 v[106:107], v[106:107], v[226:227]
    v_cvt_pk_bf16_f32 v188, v100, v101
    v_cvt_pk_bf16_f32 v189, v102, v103
    v_cvt_pk_bf16_f32 v190, v120, v121
    v_cvt_pk_bf16_f32 v191, v122, v123
    s_nop 0
    v_permlane32_swap_b32 v188, v190
    v_permlane32_swap_b32 v189, v191
    s_nop 0
    v_permlane16_swap_b32 v188, v190
    v_permlane16_swap_b32 v189, v191
    buffer_store_dwordx4 v[188:191], v13, s[64:67], s28 offen
L_c1:
    v_mov_b32 v244, 0
    s_waitcnt vmcnt(3)
    v_xor_b32 v212, s36, v212
    v_xor_b32 v213, s37, v213
    v_xor_b32 v214, s38, v214
    v_xor_b32 v215, s39, v215
    v_or3_b32 v244, v244, v212, v213
    v_or3_b32 v244, v244, v214, v215
    v_xor_b32 v216, s36, v216
    v_xor_b32 v217, s37, v217
    v_xor_b32 v218, s38, v218
    v_xor_b32 v219, s39, v219
    v_or3_b32 v244, v244, v216, v217
    v_or3_b32 v244, v244, v218, v219
    s_waitcnt vmcnt(1)
    v_xor_b32 v204, s36, v204
    v_xor_b32 v205, s37, v205
    v_xor_b32 v206, s38, v206
    v_xor_b32 v207, s39, v207
    v_or3_b32 v244, v244, v204, v205
    v_or3_b32 v244, v244, v206, v207
    v_xor_b32 v208, s36, v208
    v_xor_b32 v209, s37, v209
    v_xor_b32 v210, s38, v210
    v_xor_b32 v211, s39, v211
    v_or3_b32 v244, v244, v208, v209
    v_or3_b32 v244, v244, v210, v211
    v_and_b32 v244, 0xff, v244
    v_cmp_ne_u32 vcc, 0, v244
    s_nop 1
    s_cbranch_vccnz L_c1_slow
L_c1_done:
    v_pk_add_f32 v[84:85], v[84:85], v[212:213]
    v_pk_add_f32 v[86:87], v[86:87], v[214:215]
    v_pk_add_f32 v[104:105], v[104:105], v[216:217]
    v_pk_add_f32 v[106:107], v[106:107], v[218:219]
    v_pk_add_f32 v[84:85], v[84:85], v[204:205]
    v_pk_add_f32 v[86:87], v[86:87], v[206:207]
    v_pk_add_f32 v[104:105], v[104:105], v[208:209]
    v_pk_add_f32 v[106:107], v[106:107], v[210:211]
    v_cvt_pk_bf16_f32 v184, v84, v85
    v_cvt_pk_bf16_f32 v185, v86, v87
    v_cvt_pk_bf16_f32 v186, v104, v105
    v_cvt_pk_bf16_f32 v187, v106, v107
    s_nop 0
    v_permlane32_swap_b32 v184, v186
    v_permlane32_swap_b32 v185, v187
    s_nop 0
    v_permlane16_swap_b32 v184, v186
    v_permlane16_swap_b32 v185, v187
    buffer_store_dwordx4 v[184:187], v13, s[64:67], s27 offen
    s_andn2_b32 s3, s31, s40
    s_cmp_lg_u32 s3, 0
    s_cbranch_scc1 L_ci_w
L_noep:
L_end:
    s_endpgm
L_p1_slow:
    buffer_load_dword v77, v76, s[52:55], 0 offen sc1
    s_waitcnt vmcnt(0)
    s_sub_u32 s82, s82, 1
    s_cmp_eq_u32 s82, 0
    s_cbranch_scc0 L_p1
    s_mov_b32 s82, 1
    s_branch L_p1_done
L_a_slow:
L_a_p0:
    v_mov_b32 v14, 0
    buffer_atomic_add v14, v15, s[60:63], 0 offen sc0 sc1
    s_waitcnt vmcnt(1)
    v_and_b32 v16, 0xff, v16
    v_cmp_eq_u32 vcc, s36, v16
    s_nop 3
    s_and_b32 s3, vcc_lo, s83
    s_cmp_eq_u32 s3, s83
    s_cbranch_scc1 L_a_go
L_a_p1:
    v_mov_b32 v16, 0
    buffer_atomic_add v16, v15, s[60:63], 0 offen sc0 sc1
    s_waitcnt vmcnt(1)
    v_and_b32 v14, 0xff, v14
    v_cmp_eq_u32 vcc, s36, v14
    s_nop 3
    s_and_b32 s3, vcc_lo, s83
    s_cmp_eq_u32 s3, s83
    s_cbranch_scc1 L_a_go
    s_sub_u32 s82, s82, 1
    s_cmp_eq_u32 s82, 0
    s_cbranch_scc0 L_a_p0
    s_mov_b32 s82, 1
    s_branch L_a_go
L_c0_slow:
    buffer_load_dwordx4 v[228:231], v7, s[60:63], s24 offen offset:2048 sc1
    buffer_load_dwordx4 v[232:235], v7, s[60:63], s24 offen offset:3072 sc1
    buffer_load_dwordx4 v[236:239], v7, s[60:63], s25 offen offset:2048 sc1
    buffer_load_dwordx4 v[240:243], v7, s[60:63], s25 offen offset:3072 sc1
    buffer_load_dwordx4 v[164:167], v7, s[60:63], s26 offen offset:2048 sc1
    buffer_load_dwordx4 v[168:171], v7, s[60:63], s26 offen offset:3072 sc1
    buffer_load_dwordx4 v[220:223], v7, s[60:63], s94 offen offset:0 sc1
    buffer_load_dwordx4 v[224:227], v7, s[60:63], s94 offen offset:1024 sc1
    s_waitcnt vmcnt(0)
    s_sub_u32 s82, s82, 1
    s_cmp_eq_u32 s82, 0
    s_cbranch_scc0 L_c0
    s_mov_b32 s82, 1
    s_branch L_c0_done
L_c1_slow:
    buffer_load_dwordx4 v[212:215], v7, s[60:63], s93 offen offset:0 sc1
    buffer_load_dwordx4 v[216:219], v7, s[60:63], s93 offen offset:1024 sc1
    buffer_load_dwordx4 v[204:207], v7, s[60:63], s92 offen offset:0 sc1
    buffer_load_dwordx4 v[208:211], v7, s[60:63], s92 offen offset:1024 sc1
    s_waitcnt vmcnt(0)
    s_sub_u32 s82, s82, 1
    s_cmp_eq_u32 s82, 0
    s_cbranch_scc0 L_c1
    s_mov_b32 s82, 1
    s_branch L_c1_done
L_ci_w:
    buffer_load_dword v204, v61, s[52:55], 0 offen offset:0 sc1
    buffer_load_dword v205, v61, s[52:55], 0 offen offset:4 sc1
    buffer_load_dword v206, v61, s[52:55], 0 offen offset:8 sc1
    buffer_load_dword v207, v61, s[52:55], 0 offen offset:12 sc1
    s_waitcnt vmcnt(0)
    v_xor_b32 v204, v30, v204
    v_xor_b32 v205, v30, v205
    v_xor_b32 v206, v30, v206
    v_xor_b32 v207, v30, v207
    v_or_b32 v9, v204, v205
    v_or3_b32 v9, v9, v206, v207
    v_cmp_ne_u32 vcc, 0, v9
    s_nop 1
    s_cbranch_vccz L_ci_done
    s_sub_u32 s82, s82, 1
    s_cmp_eq_u32 s82, 0
    s_cbranch_scc0 L_ci_w
    s_mov_b32 s82, 1
    s_branch L_ci_done
L_ci_done:
    buffer_store_dword v26, v29, s[52:55], 0 offen sc1
    s_branch L_noep
L_last:
    s_endpgm
.section .rodata,"a"
.p2align 6
.amdhsa_kernel standalone__mha_block_cached__near_ridge_kernel
  .amdhsa_next_free_vgpr 508
  .amdhsa_next_free_sgpr 100
  .amdhsa_accum_offset 252
  .amdhsa_group_segment_fixed_size 0
  .amdhsa_kernarg_size 64
  .amdhsa_user_sgpr_count 2
  .amdhsa_user_sgpr_kernarg_segment_ptr 1
  .amdhsa_system_sgpr_workgroup_id_x 1
  .amdhsa_float_denorm_mode_32 3
.end_amdhsa_kernel
```
